```python
import torch

def _softmax(x, axis=-1):
    return torch.softmax(x, dim=axis)
def _gelu(x):
    return torch.nn.functional.gelu(x, approximate="tanh")
def _silu(x):
    return torch.nn.functional.silu(x)
def _sigmoid(x):
    return torch.sigmoid(x)
def _layernorm(x, axis=-1, eps=1e-5):
    m = x.mean(dim=axis, keepdim=True)
    v = x.var(dim=axis, keepdim=True, unbiased=False)
    return (x - m) / torch.sqrt(v + eps)
def _scatter_add(tgt, idx, src, axis=0):
    return tgt.clone().index_add_(axis, idx, src)
def _segment_sum(src, seg, n):
    out = torch.zeros((n,) + src.shape[1:], dtype=src.dtype)
    return out.index_add_(0, seg, src)
def _pad(x, pw):
    flat = tuple(v for pair in reversed(pw) for v in pair)
    return torch.nn.functional.pad(x, flat)

kernel_name = 'sequential_preLN__mha_block_cached__dense_activation_silu__decode'

def setup_inputs():

    _w = (lambda a: (lambda t: t.to(torch.bfloat16) if t.is_floating_point() else t)(torch.as_tensor(a)))
    def _A_setup():
        B, Sq, D = 2, 1, 512
        H, Sk, Dh = 32, 4096, 128
        return {
            "x": _w((lambda *s: torch.randn(*s, dtype=torch.bfloat16) * 0.1)(B, Sq, D)),
            "k_cache": _w((lambda *s: torch.randn(*s, dtype=torch.bfloat16) * 1.6)(B, H, Sk, Dh)),
            "v_cache": _w((lambda *s: torch.randn(*s, dtype=torch.bfloat16) * 1.6)(B, H, Sk, Dh)),
            "wq": _w((lambda *s: torch.randn(*s, dtype=torch.bfloat16) * 1.6)(D, H * Dh) * (D ** -0.5)),
            "wo": _w((lambda *s: torch.randn(*s, dtype=torch.bfloat16) * 1.6)(H * Dh, D) * ((H * Dh) ** -0.5)),
        }
    _A_in = _A_setup()

    def _B_setup():
        B, S, D, F = 2, 1, 512, 1376
        return {
            "x": _w((lambda *s: torch.randn(*s, dtype=torch.bfloat16) * 0.1)(B, S, D)),
            "w1": _w((lambda *s: torch.randn(*s, dtype=torch.bfloat16) * 3.2)(D, F) * (D ** -0.5)),
            "w2": _w((lambda *s: torch.randn(*s, dtype=torch.bfloat16) * 3.2)(F, D) * (F ** -0.5)),
        }
    _B_in = _B_setup()

    return {
        "A_x": _A_in["x"],
        "A_k_cache": _A_in["k_cache"],
        "A_v_cache": _A_in["v_cache"],
        "A_wq": _A_in["wq"],
        "A_wo": _A_in["wo"],
        "B_x": _B_in["x"],
        "B_w1": _B_in["w1"],
        "B_w2": _B_in["w2"],
    }

def reference(A_x, A_k_cache, A_v_cache, A_wq, A_wo, B_x, B_w1, B_w2):
    def _A_ref(x, k_cache, v_cache, wq, wo):
        B, Sq, D = x.shape
        H, Dh = 32, 128
        q = (lambda x, *d: x.permute(*d))((x @ wq).reshape(B, Sq, H, Dh), 0, 2, 1, 3)
        scores = torch.einsum("bhqd,bhkd->bhqk", q, k_cache) * (Dh ** -0.5)
        p = _softmax(scores, axis=-1)
        o = torch.einsum("bhqk,bhkd->bhqd", p, v_cache)
        return (lambda x, *d: x.permute(*d))(o, 0, 2, 1, 3).reshape(B, Sq, H * Dh) @ wo

    def _B_ref(x, w1, w2):
        h = torch.einsum("bsd,df->bsf", x, w1)
        h = _silu(h)
        out = torch.einsum("bsf,fd->bsd", h, w2)
        return out

    x = A_x
    h = x + _A_ref(_layernorm(x, axis=-1), A_k_cache, A_v_cache, A_wq, A_wo)
    h2 = h + _B_ref(_layernorm(h, axis=-1), B_w1, B_w2)
    return h2
```

```asm
; @launch grid=(256,1,1) block=(1024,1,1) lds=88320
.amdgcn_target "amdgcn-amd-amdhsa--gfx950"
.text
.globl sequential_preLN__mha_block_cached__dense_activation_silu__decode_kernel
.p2align 8
.type sequential_preLN__mha_block_cached__dense_activation_silu__decode_kernel,@function
sequential_preLN__mha_block_cached__dense_activation_silu__decode_kernel:
  s_load_dwordx16 s[16:31], s[0:1], 0
  s_load_dwordx4 s[32:35], s[0:1], 64
  s_load_dwordx2 s[36:37], s[0:1], 80
  s_cmp_ge_u32 s2, 256
  s_cbranch_scc1 L_END
  v_and_b32 v1, 63, v0
  v_lshrrev_b32 v5, 6, v0
  v_and_b32 v2, 15, v0
  v_readfirstlane_b32 s3, v5
  v_bfe_u32 v3, v0, 4, 2
  s_and_b32 s11, s2, 7
  s_lshr_b32 s12, s2, 3
  s_and_b32 s4, s12, 1
  s_bfe_u32 s5, s12, 0x10001
  s_bfe_u32 s7, s12, 0x10002
  s_lshr_b32 s13, s12, 3
  s_lshl_b32 s8, s11, 2
  s_add_u32 s8, s8, s13
  s_lshl_b32 s6, s7, 5
  s_add_u32 s6, s6, s8
  s_lshl_b32 s9, s5, 1
  s_add_u32 s9, s9, s4
  v_lshlrev_b32 v4, 4, v1
  s_lshl_b32 s11, s3, 15
  v_add_u32 v4, s11, v4
  s_cmp_eq_u32 s4, 0
  s_mov_b32 s11, 1024
  s_cselect_b32 s11, s11, -1024
  s_mov_b32 s93, 16
  s_cselect_b32 s93, s93, 16
  s_mul_i32 s76, s4, 31744
  s_add_u32 s77, s76, s11
  s_add_u32 s78, s77, s11
  s_add_u32 s79, s78, s11
  s_add_u32 s80, s79, s11
  s_add_u32 s81, s80, s11
  s_add_u32 s82, s81, s11
  s_add_u32 s83, s82, s11
  s_add_u32 s84, s83, s11
  s_add_u32 s85, s84, s11
  s_add_u32 s86, s85, s11
  s_add_u32 s87, s86, s11
  s_add_u32 s88, s87, s11
  s_add_u32 s89, s88, s11
  s_add_u32 s90, s89, s11
  s_add_u32 s91, s90, s11
  s_waitcnt lgkmcnt(0)
  s_load_dword s10, s[36:37], 0x30000
  s_setprio 3
  s_lshl_b32 s11, s6, 20
  s_lshl_b32 s12, s5, 19
  s_add_u32 s11, s11, s12
  s_add_u32 s40, s18, s11
  s_addc_u32 s41, s19, 0
  s_mov_b32 s42, 0x80000
  s_mov_b32 s43, 0x20000
  buffer_load_dwordx4 v[28:31], v4, s[40:43], s76 offen nt
  buffer_load_dwordx4 v[32:35], v4, s[40:43], s77 offen nt
  buffer_load_dwordx4 v[36:39], v4, s[40:43], s78 offen nt
  buffer_load_dwordx4 v[40:43], v4, s[40:43], s79 offen nt
  s_add_u32 s44, s20, s11
  s_addc_u32 s45, s21, 0
  s_mov_b32 s46, 0x80000
  s_mov_b32 s47, 0x20000
  s_mov_b32 s52, s16
  s_mov_b32 s53, s17
  s_mov_b32 s54, 2048
  s_mov_b32 s55, 0x20000
  s_lshl_b32 s11, s8, 8
  s_sub_u32 s12, 0x400000, s11
  s_add_u32 s56, s22, s11
  s_addc_u32 s57, s23, 0
  s_mov_b32 s58, s12
  s_mov_b32 s59, 0x20000
  s_lshr_b32 s11, s2, 3
  s_and_b32 s11, s11, 7
  s_mul_i32 s11, s11, 2
  s_add_u32 s11, s11, s3
  s_and_b32 s26, s11, 15
  v_lshlrev_b32 v5, 4, v1
  s_lshl_b32 s12, s7, 10
  buffer_load_dwordx4 v[8:11], v5, s[52:55], s12 offen
  s_lshl_b32 s11, s26, 5
  v_lshl_add_u32 v6, v3, 1, s11
  v_lshlrev_b32 v7, 13, v6
  v_lshl_add_u32 v7, v2, 4, v7
  s_mov_b32 s13, 0
  buffer_load_dwordx4 v[96:99], v7, s[56:59], s13 offen
  s_mov_b32 s13, 8192
  buffer_load_dwordx4 v[100:103], v7, s[56:59], s13 offen
  v_lshlrev_b32 v5, 2, v1
  v_mov_b32 v6, 0
  s_mov_b64 exec, 15
  ds_write_b32 v5, v6 offset:8576
  s_mov_b64 exec, -1
  s_waitcnt lgkmcnt(0)
  s_barrier
  s_mov_b32 s13, 65536
  buffer_load_dwordx4 v[104:107], v7, s[56:59], s13 offen
  s_mov_b32 s13, 73728
  buffer_load_dwordx4 v[108:111], v7, s[56:59], s13 offen
  s_mov_b32 s13, 131072
  buffer_load_dwordx4 v[112:115], v7, s[56:59], s13 offen
  s_mov_b32 s13, 139264
  buffer_load_dwordx4 v[116:119], v7, s[56:59], s13 offen
  s_mov_b32 s13, 196608
  buffer_load_dwordx4 v[120:123], v7, s[56:59], s13 offen
  s_mov_b32 s13, 204800
  buffer_load_dwordx4 v[124:127], v7, s[56:59], s13 offen
  s_setprio 2
  s_cmp_ge_u32 s3, 4
  s_cbranch_scc1 BW_1
  buffer_load_dwordx4 v[44:47], v4, s[40:43], s80 offen nt
  buffer_load_dwordx4 v[48:51], v4, s[40:43], s81 offen nt
  buffer_load_dwordx4 v[52:55], v4, s[40:43], s82 offen nt
  buffer_load_dwordx4 v[56:59], v4, s[40:43], s83 offen nt
  buffer_load_dwordx4 v[60:63], v4, s[40:43], s84 offen nt
  buffer_load_dwordx4 v[64:67], v4, s[40:43], s85 offen nt
  buffer_load_dwordx4 v[68:71], v4, s[40:43], s86 offen nt
  buffer_load_dwordx4 v[72:75], v4, s[40:43], s87 offen nt
  buffer_load_dwordx4 v[76:79], v4, s[40:43], s88 offen nt
  buffer_load_dwordx4 v[80:83], v4, s[40:43], s89 offen nt
  buffer_load_dwordx4 v[84:87], v4, s[40:43], s90 offen nt
BW_1:
  s_mov_b32 s48, s36
  s_mov_b32 s49, s37
  s_mov_b32 s50, 0x400000
  s_mov_b32 s51, 0x20000
  s_mov_b32 s72, s34
  s_mov_b32 s73, s35
  s_mov_b32 s74, 256
  s_mov_b32 s75, 0x20000
  s_mov_b32 s68, s32
  s_mov_b32 s69, s33
  s_mov_b32 s70, 2048
  s_mov_b32 s71, 0x20000
  s_and_b32 s11, s2, 7
  s_lshr_b32 s12, s11, 1
  s_lshl_b32 s12, s12, 4
  s_lshr_b32 s13, s2, 4
  s_add_u32 s12, s12, s13
  s_and_b32 s11, s11, 1
  s_bfe_u32 s13, s2, 0x10003
  s_lshl_b32 s13, s13, 1
  s_add_u32 s11, s11, s13
  s_mov_b32 s27, 0
  s_mov_b32 s95, s12
  s_cmp_eq_u32 s11, 1
  s_cselect_b32 s27, 3, s27
  s_cmp_lt_u32 s12, 43
  s_cselect_b32 s13, 2, 0
  s_cmp_eq_u32 s11, 2
  s_cselect_b32 s27, s13, s27
  s_add_u32 s13, s12, 16
  s_and_b32 s13, s13, 63
  s_cmp_eq_u32 s11, 0
  s_cselect_b32 s27, 1, s27
  s_cselect_b32 s95, s13, s95
  s_lshr_b32 s101, s95, 1
  s_cmp_eq_u32 s27, 2
  s_cbranch_scc1 RF_2
  s_lshl_b32 s11, s95, 16
  s_add_u32 s60, s24, s11
  s_addc_u32 s61, s25, 0
  s_mov_b32 s62, 65536
  s_mov_b32 s63, 0x20000
  s_add_u32 s64, s24, s11
  s_addc_u32 s65, s25, 0
  s_mov_b32 s66, 0
  s_mov_b32 s67, 0x20000
  s_branch RDONE_3
RF_2:
  s_lshl_b32 s11, s95, 6
  s_sub_u32 s12, 0x158000, s11
  s_add_u32 s60, s28, s11
  s_addc_u32 s61, s29, 0
  s_mov_b32 s62, s12
  s_mov_b32 s63, 0x20000
  s_lshl_b32 s11, s95, 15
  s_add_u32 s64, s30, s11
  s_addc_u32 s65, s31, 0
  s_mov_b32 s66, 32768
  s_mov_b32 s67, 0x20000
RDONE_3:
  s_cmp_eq_u32 s3, 1
  s_cbranch_scc0 NT_4
  v_mov_b32 v5, 0
  s_mov_b64 exec, 1
  s_mov_b32 s11, 0x50000
  buffer_load_dword v0, v5, s[44:47], 0 offen nt
  buffer_load_dword v0, v5, s[48:51], s11 offen sc1
  buffer_load_dword v0, v5, s[60:63], 0 offen nt
  buffer_load_dword v0, v5, s[64:67], 0 offen nt
  buffer_load_dword v0, v5, s[68:71], 0 offen nt
  s_mov_b64 exec, -1
  s_waitcnt vmcnt(63)
NT_4:
  s_mov_b32 s15, 0x3f803f80
  s_cmp_ge_u32 s3, 4
  s_cbranch_scc1 WD_5
  s_waitcnt vmcnt(19)
  s_branch WDJ_6
WD_5:
  s_waitcnt vmcnt(8)
WDJ_6:
  s_mov_b32 s15, 0x3f803f80
  v_dot2_f32_bf16 v22, v8, s15, 0
  v_dot2_f32_bf16 v23, v8, v8, 0
  v_dot2_f32_bf16 v22, v9, s15, v22
  v_dot2_f32_bf16 v23, v9, v9, v23
  v_dot2_f32_bf16 v22, v10, s15, v22
  v_dot2_f32_bf16 v23, v10, v10, v23
  v_dot2_f32_bf16 v22, v11, s15, v22
  v_dot2_f32_bf16 v23, v11, v11, v23
  s_nop 1
  v_add_f32_dpp v22, v22, v22 row_ror:8 row_mask:0xf bank_mask:0xf
  v_add_f32_dpp v23, v23, v23 row_ror:8 row_mask:0xf bank_mask:0xf
  s_nop 0
  v_add_f32_dpp v22, v22, v22 row_ror:4 row_mask:0xf bank_mask:0xf
  v_add_f32_dpp v23, v23, v23 row_ror:4 row_mask:0xf bank_mask:0xf
  s_nop 0
  v_add_f32_dpp v22, v22, v22 row_ror:2 row_mask:0xf bank_mask:0xf
  v_add_f32_dpp v23, v23, v23 row_ror:2 row_mask:0xf bank_mask:0xf
  s_nop 0
  v_add_f32_dpp v22, v22, v22 row_ror:1 row_mask:0xf bank_mask:0xf
  v_add_f32_dpp v23, v23, v23 row_ror:1 row_mask:0xf bank_mask:0xf
  s_nop 0
  v_add_f32_dpp v22, v22, v22 row_bcast:15 row_mask:0xa bank_mask:0xf
  v_add_f32_dpp v23, v23, v23 row_bcast:15 row_mask:0xa bank_mask:0xf
  s_nop 0
  v_add_f32_dpp v22, v22, v22 row_bcast:31 row_mask:0xc bank_mask:0xf
  v_add_f32_dpp v23, v23, v23 row_bcast:31 row_mask:0xc bank_mask:0xf
  v_readlane_b32 s11, v22, 63
  v_readlane_b32 s12, v23, 63
  s_nop 0
  v_mov_b32 v22, s11
  v_mov_b32 v23, s12
  v_mul_f32 v22, 0x3b000000, v22
  v_mul_f32 v23, 0x3b000000, v23
  v_fma_f32 v23, -v22, v22, v23
  v_max_f32 v23, 0, v23
  v_cvt_pk_bf16_f32 v26, v22, v23
  v_lshlrev_b32 v22, 16, v26
  v_and_b32 v23, 0xffff0000, v26
  v_add_f32 v23, 0x3727c5ac, v23
  v_cvt_pk_bf16_f32 v26, v23, v23
  v_lshlrev_b32 v23, 16, v26
  v_sqrt_f32 v23, v23
  s_nop 0
  v_cvt_pk_bf16_f32 v26, v23, v23
  v_lshlrev_b32 v23, 16, v26
  v_rcp_f32 v23, v23
  v_lshlrev_b32 v12, 16, v8
  v_and_b32 v13, 0xffff0000, v8
  v_lshlrev_b32 v14, 16, v9
  v_and_b32 v15, 0xffff0000, v9
  v_lshlrev_b32 v16, 16, v10
  v_and_b32 v17, 0xffff0000, v10
  v_lshlrev_b32 v18, 16, v11
  v_and_b32 v19, 0xffff0000, v11
  v_sub_f32 v12, v12, v22
  v_sub_f32 v13, v13, v22
  v_sub_f32 v14, v14, v22
  v_sub_f32 v15, v15, v22
  v_sub_f32 v16, v16, v22
  v_sub_f32 v17, v17, v22
  v_sub_f32 v18, v18, v22
  v_sub_f32 v19, v19, v22
  v_cvt_pk_bf16_f32 v8, v12, v13
  v_cvt_pk_bf16_f32 v9, v14, v15
  v_cvt_pk_bf16_f32 v10, v16, v17
  v_cvt_pk_bf16_f32 v11, v18, v19
  v_lshlrev_b32 v12, 16, v8
  v_and_b32 v13, 0xffff0000, v8
  v_lshlrev_b32 v14, 16, v9
  v_and_b32 v15, 0xffff0000, v9
  v_lshlrev_b32 v16, 16, v10
  v_and_b32 v17, 0xffff0000, v10
  v_lshlrev_b32 v18, 16, v11
  v_and_b32 v19, 0xffff0000, v11
  v_mul_f32 v12, v12, v23
  v_mul_f32 v13, v13, v23
  v_mul_f32 v14, v14, v23
  v_mul_f32 v15, v15, v23
  v_mul_f32 v16, v16, v23
  v_mul_f32 v17, v17, v23
  v_mul_f32 v18, v18, v23
  v_mul_f32 v19, v19, v23
  v_cvt_pk_bf16_f32 v8, v12, v13
  v_cvt_pk_bf16_f32 v9, v14, v15
  v_cvt_pk_bf16_f32 v10, v16, v17
  v_cvt_pk_bf16_f32 v11, v18, v19
  v_lshlrev_b32 v5, 4, v1
  s_lshl_b32 s11, s3, 10
  v_add_u32 v5, s11, v5
  ds_write_b128 v5, v[8:11] offset:20480
  s_lshl_b32 s12, s26, 6
  s_add_u32 s11, s11, s12
  v_lshlrev_b32 v5, 2, v3
  v_add_u32 v5, s11, v5
  s_waitcnt lgkmcnt(0)
  ds_read_b32 v12, v5 offset:20480
  ds_read_b32 v13, v5 offset:20496
  ds_read_b32 v14, v5 offset:20512
  ds_read_b32 v15, v5 offset:20528
  s_mov_b32 s13, 0x05040100
  s_mov_b32 s14, 0x07060302
  s_waitcnt lgkmcnt(0)
  s_cmp_ge_u32 s3, 4
  s_cbranch_scc1 WD_7
  s_waitcnt vmcnt(17)
  s_branch WDJ_8
WD_7:
  s_waitcnt vmcnt(6)
WDJ_8:
  v_perm_b32 v88, v100, v96, s13
  v_perm_b32 v89, v100, v96, s14
  v_perm_b32 v90, v101, v97, s13
  v_perm_b32 v91, v101, v97, s14
  v_perm_b32 v92, v102, v98, s13
  v_perm_b32 v93, v102, v98, s14
  v_perm_b32 v94, v103, v99, s13
  v_perm_b32 v95, v103, v99, s14
  v_dot2_f32_bf16 v20, v88, v12, 0
  v_dot2_f32_bf16 v21, v89, v12, 0
  v_dot2_f32_bf16 v22, v90, v12, 0
  v_dot2_f32_bf16 v23, v91, v12, 0
  v_dot2_f32_bf16 v24, v92, v12, 0
  v_dot2_f32_bf16 v25, v93, v12, 0
  v_dot2_f32_bf16 v26, v94, v12, 0
  v_dot2_f32_bf16 v27, v95, v12, 0
  s_cmp_ge_u32 s3, 4
  s_cbranch_scc1 WD_9
  s_waitcnt vmcnt(15)
  s_branch WDJ_10
WD_9:
  s_waitcnt vmcnt(4)
WDJ_10:
  v_perm_b32 v88, v108, v104, s13
  v_perm_b32 v89, v108, v104, s14
  v_perm_b32 v90, v109, v105, s13
  v_perm_b32 v91, v109, v105, s14
  v_perm_b32 v92, v110, v106, s13
  v_perm_b32 v93, v110, v106, s14
  v_perm_b32 v94, v111, v107, s13
  v_perm_b32 v95, v111, v107, s14
  v_dot2_f32_bf16 v20, v88, v13, v20
  v_dot2_f32_bf16 v21, v89, v13, v21
  v_dot2_f32_bf16 v22, v90, v13, v22
  v_dot2_f32_bf16 v23, v91, v13, v23
  v_dot2_f32_bf16 v24, v92, v13, v24
  v_dot2_f32_bf16 v25, v93, v13, v25
  v_dot2_f32_bf16 v26, v94, v13, v26
  v_dot2_f32_bf16 v27, v95, v13, v27
  s_cmp_ge_u32 s3, 4
  s_cbranch_scc1 WD_11
  s_waitcnt vmcnt(13)
  s_branch WDJ_12
WD_11:
  s_waitcnt vmcnt(2)
WDJ_12:
  v_perm_b32 v88, v116, v112, s13
  v_perm_b32 v89, v116, v112, s14
  v_perm_b32 v90, v117, v113, s13
  v_perm_b32 v91, v117, v113, s14
  v_perm_b32 v92, v118, v114, s13
  v_perm_b32 v93, v118, v114, s14
  v_perm_b32 v94, v119, v115, s13
  v_perm_b32 v95, v119, v115, s14
  v_dot2_f32_bf16 v20, v88, v14, v20
  v_dot2_f32_bf16 v21, v89, v14, v21
  v_dot2_f32_bf16 v22, v90, v14, v22
  v_dot2_f32_bf16 v23, v91, v14, v23
  v_dot2_f32_bf16 v24, v92, v14, v24
  v_dot2_f32_bf16 v25, v93, v14, v25
  v_dot2_f32_bf16 v26, v94, v14, v26
  v_dot2_f32_bf16 v27, v95, v14, v27
  s_cmp_ge_u32 s3, 4
  s_cbranch_scc1 WD_13
  s_waitcnt vmcnt(11)
  s_branch WDJ_14
WD_13:
  s_waitcnt vmcnt(0)
WDJ_14:
  v_perm_b32 v88, v124, v120, s13
  v_perm_b32 v89, v124, v120, s14
  v_perm_b32 v90, v125, v121, s13
  v_perm_b32 v91, v125, v121, s14
  v_perm_b32 v92, v126, v122, s13
  v_perm_b32 v93, v126, v122, s14
  v_perm_b32 v94, v127, v123, s13
  v_perm_b32 v95, v127, v123, s14
  v_dot2_f32_bf16 v20, v88, v15, v20
  v_dot2_f32_bf16 v21, v89, v15, v21
  v_dot2_f32_bf16 v22, v90, v15, v22
  v_dot2_f32_bf16 v23, v91, v15, v23
  v_dot2_f32_bf16 v24, v92, v15, v24
  v_dot2_f32_bf16 v25, v93, v15, v25
  v_dot2_f32_bf16 v26, v94, v15, v26
  v_dot2_f32_bf16 v27, v95, v15, v27
  v_permlane32_swap_b32 v20, v21
  v_permlane32_swap_b32 v22, v23
  v_permlane32_swap_b32 v24, v25
  v_permlane32_swap_b32 v26, v27
  v_add_f32 v20, v20, v21
  v_add_f32 v22, v22, v23
  v_add_f32 v24, v24, v25
  v_add_f32 v26, v26, v27
  v_permlane16_swap_b32 v20, v22
  s_nop 0
  v_permlane16_swap_b32 v24, v26
  v_add_f32 v8, v20, v22
  v_add_f32 v9, v24, v26
  v_and_b32 v6, 1, v3
  v_lshlrev_b32 v6, 1, v6
  v_lshrrev_b32 v7, 1, v3
  v_or_b32 v6, v6, v7
  v_lshl_add_u32 v5, v2, 3, v6
  v_lshlrev_b32 v5, 2, v5
  s_lshl_b32 s11, s3, 9
  v_add_u32 v5, s11, v5
  ds_write_b32 v5, v8 offset:0
  ds_write_b32 v5, v9 offset:16
  s_waitcnt lgkmcnt(0)
  v_mov_b32 v6, 8580
  v_mov_b32 v7, 1
  s_mov_b64 exec, 1
  ds_add_rtn_u32 v5, v6, v7
  s_mov_b64 exec, -1
  s_waitcnt lgkmcnt(0)
  v_readfirstlane_b32 s11, v5
  s_nop 0
  s_cmp_eq_u32 s11, 15
  s_cbranch_scc0 NOTLAST_15
  v_and_b32 v5, 31, v1
  v_lshlrev_b32 v5, 4, v5
  v_lshrrev_b32 v6, 5, v1
  v_lshlrev_b32 v6, 12, v6
  v_add_u32 v5, v5, v6
  ds_read_b128 v[96:99], v5 offset:0
  ds_read_b128 v[100:103], v5 offset:512
  ds_read_b128 v[104:107], v5 offset:1024
  ds_read_b128 v[108:111], v5 offset:1536
  ds_read_b128 v[112:115], v5 offset:2048
  ds_read_b128 v[116:119], v5 offset:2560
  ds_read_b128 v[120:123], v5 offset:3072
  ds_read_b128 v[124:127], v5 offset:3584
  s_waitcnt lgkmcnt(0)
  v_add_f32 v96, v96, v100
  v_add_f32 v104, v104, v108
  v_add_f32 v112, v112, v116
  v_add_f32 v120, v120, v124
  v_add_f32 v97, v97, v101
  v_add_f32 v105, v105, v109
  v_add_f32 v113, v113, v117
  v_add_f32 v121, v121, v125
  v_add_f32 v98, v98, v102
  v_add_f32 v106, v106, v110
  v_add_f32 v114, v114, v118
  v_add_f32 v122, v122, v126
  v_add_f32 v99, v99, v103
  v_add_f32 v107, v107, v111
  v_add_f32 v115, v115, v119
  v_add_f32 v123, v123, v127
  v_add_f32 v96, v96, v104
  v_add_f32 v112, v112, v120
  v_add_f32 v97, v97, v105
  v_add_f32 v113, v113, v121
  v_add_f32 v98, v98, v106
  v_add_f32 v114, v114, v122
  v_add_f32 v99, v99, v107
  v_add_f32 v115, v115, v123
  v_add_f32 v96, v96, v112
  v_add_f32 v97, v97, v113
  v_add_f32 v98, v98, v114
  v_add_f32 v99, v99, v115
  v_mov_b32 v100, v96
  v_mov_b32 v101, v97
  v_mov_b32 v102, v98
  v_mov_b32 v103, v99
  v_permlane32_swap_b32 v96, v100
  v_permlane32_swap_b32 v97, v101
  v_permlane32_swap_b32 v98, v102
  v_permlane32_swap_b32 v99, v103
  v_add_f32 v96, v96, v100
  v_add_f32 v97, v97, v101
  v_add_f32 v98, v98, v102
  v_add_f32 v99, v99, v103
  v_cvt_pk_bf16_f32 v104, v96, v97
  v_cvt_pk_bf16_f32 v105, v98, v99
  v_and_b32 v5, 31, v1
  v_lshlrev_b32 v5, 3, v5
  ds_write_b64 v5, v[104:105] offset:8192
  s_waitcnt lgkmcnt(0)
  v_mov_b32 v6, 8584
  v_mov_b32 v7, 1
  ds_write_b32 v6, v7
NOTLAST_15:
  s_cmp_ge_u32 s3, 4
  s_cbranch_scc0 BW2_16
  s_setprio 2
  buffer_load_dwordx4 v[44:47], v4, s[40:43], s80 offen nt
  buffer_load_dwordx4 v[48:51], v4, s[40:43], s81 offen nt
  buffer_load_dwordx4 v[52:55], v4, s[40:43], s82 offen nt
  buffer_load_dwordx4 v[56:59], v4, s[40:43], s83 offen nt
  buffer_load_dwordx4 v[60:63], v4, s[40:43], s84 offen nt
  buffer_load_dwordx4 v[64:67], v4, s[40:43], s85 offen nt
  buffer_load_dwordx4 v[68:71], v4, s[40:43], s86 offen nt
  buffer_load_dwordx4 v[72:75], v4, s[40:43], s87 offen nt
  buffer_load_dwordx4 v[76:79], v4, s[40:43], s88 offen nt
  buffer_load_dwordx4 v[80:83], v4, s[40:43], s89 offen nt
  buffer_load_dwordx4 v[84:87], v4, s[40:43], s90 offen nt
BW2_16:
  s_setprio 1
  buffer_load_dwordx4 v[88:91], v4, s[40:43], s91 offen nt
  s_setprio 1
  v_mov_b32 v6, 8584
  ds_read_b32 v7, v6
  s_waitcnt lgkmcnt(0)
  v_readfirstlane_b32 s100, v7
  s_nop 0
  s_cmp_ge_u32 s100, 1
  s_cbranch_scc1 KPH_18
  buffer_load_dwordx4 v[96:99], v4, s[44:47], s76 offen nt
  buffer_load_dwordx4 v[100:103], v4, s[44:47], s77 offen nt
  buffer_load_dwordx4 v[104:107], v4, s[44:47], s78 offen nt
  buffer_load_dwordx4 v[108:111], v4, s[44:47], s79 offen nt
  buffer_load_dwordx4 v[112:115], v4, s[44:47], s80 offen nt
  buffer_load_dwordx4 v[116:119], v4, s[44:47], s81 offen nt
  buffer_load_dwordx4 v[120:123], v4, s[44:47], s82 offen nt
  buffer_load_dwordx4 v[124:127], v4, s[44:47], s83 offen nt
  v_mov_b32 v6, 8584
LW_20:
  ds_read_b32 v7, v6
  s_waitcnt lgkmcnt(0)
  v_readfirstlane_b32 s15, v7
  s_nop 0
  s_cmp_ge_u32 s15, 1
  s_cbranch_scc1 LWOK_21
  s_sleep 1
  s_branch LW_20
LWOK_21:
KPH_18:
  s_setprio 1
  v_lshlrev_b32 v5, 4, v2
  ds_read_b128 v[8:11], v5 offset:8192
  s_mov_b32 s96, 0x00010001
  s_mov_b32 s97, 0x00010001
  v_mov_b32 v16, 0
  s_waitcnt lgkmcnt(0)
  v_mov_b32 v17, 0
  s_waitcnt vmcnt(21)
  v_dot2_f32_bf16 v12, v28, v8, 0
  v_dot2_f32_bf16 v13, v32, v8, 0
  v_dot2_f32_bf16 v14, v36, v8, 0
  v_dot2_f32_bf16 v15, v40, v8, 0
  v_dot2_f32_bf16 v12, v29, v9, v12
  v_dot2_f32_bf16 v13, v33, v9, v13
  v_dot2_f32_bf16 v14, v37, v9, v14
  v_dot2_f32_bf16 v15, v41, v9, v15
  v_dot2_f32_bf16 v12, v30, v10, v12
  v_dot2_f32_bf16 v13, v34, v10, v13
  v_dot2_f32_bf16 v14, v38, v10, v14
  v_dot2_f32_bf16 v15, v42, v10, v15
  v_dot2_f32_bf16 v12, v31, v11, v12
  v_dot2_f32_bf16 v13, v35, v11, v13
  v_dot2_f32_bf16 v14, v39, v11, v14
  v_dot2_f32_bf16 v15, v43, v11, v15
  v_add_f32_dpp v12, v12, v12 row_ror:8 row_mask:0xf bank_mask:0xf
  v_add_f32_dpp v13, v13, v13 row_ror:8 row_mask:0xf bank_mask:0xf
  v_add_f32_dpp v14, v14, v14 row_ror:8 row_mask:0xf bank_mask:0xf
  v_add_f32_dpp v15, v15, v15 row_ror:8 row_mask:0xf bank_mask:0xf
  v_add_f32_dpp v12, v12, v12 row_ror:4 row_mask:0xf bank_mask:0xf
  v_add_f32_dpp v13, v13, v13 row_ror:4 row_mask:0xf bank_mask:0xf
  v_add_f32_dpp v14, v14, v14 row_ror:4 row_mask:0xf bank_mask:0xf
  v_add_f32_dpp v15, v15, v15 row_ror:4 row_mask:0xf bank_mask:0xf
  v_add_f32_dpp v12, v12, v12 row_ror:2 row_mask:0xf bank_mask:0xf
  v_add_f32_dpp v13, v13, v13 row_ror:2 row_mask:0xf bank_mask:0xf
  v_add_f32_dpp v14, v14, v14 row_ror:2 row_mask:0xf bank_mask:0xf
  v_add_f32_dpp v15, v15, v15 row_ror:2 row_mask:0xf bank_mask:0xf
  v_add_f32_dpp v12, v12, v12 row_ror:1 row_mask:0xf bank_mask:0xf
  v_add_f32_dpp v13, v13, v13 row_ror:1 row_mask:0xf bank_mask:0xf
  v_add_f32_dpp v14, v14, v14 row_ror:1 row_mask:0xf bank_mask:0xf
  v_add_f32_dpp v15, v15, v15 row_ror:1 row_mask:0xf bank_mask:0xf
  v_cndmask_b32 v16, v16, v12, s[96:97]
  s_lshl_b64 s[96:97], s[96:97], 1
  v_cndmask_b32 v16, v16, v13, s[96:97]
  s_lshl_b64 s[96:97], s[96:97], 1
  v_cndmask_b32 v16, v16, v14, s[96:97]
  s_lshl_b64 s[96:97], s[96:97], 1
  v_cndmask_b32 v16, v16, v15, s[96:97]
  s_lshl_b64 s[96:97], s[96:97], 1
  s_waitcnt vmcnt(8)
  v_dot2_f32_bf16 v12, v44, v8, 0
  v_dot2_f32_bf16 v13, v48, v8, 0
  v_dot2_f32_bf16 v14, v52, v8, 0
  v_dot2_f32_bf16 v15, v56, v8, 0
  v_dot2_f32_bf16 v12, v45, v9, v12
  v_dot2_f32_bf16 v13, v49, v9, v13
  v_dot2_f32_bf16 v14, v53, v9, v14
  v_dot2_f32_bf16 v15, v57, v9, v15
  v_dot2_f32_bf16 v12, v46, v10, v12
  v_dot2_f32_bf16 v13, v50, v10, v13
  v_dot2_f32_bf16 v14, v54, v10, v14
  v_dot2_f32_bf16 v15, v58, v10, v15
  v_dot2_f32_bf16 v12, v47, v11, v12
  v_dot2_f32_bf16 v13, v51, v11, v13
  v_dot2_f32_bf16 v14, v55, v11, v14
  v_dot2_f32_bf16 v15, v59, v11, v15
  v_add_f32_dpp v12, v12, v12 row_ror:8 row_mask:0xf bank_mask:0xf
  v_add_f32_dpp v13, v13, v13 row_ror:8 row_mask:0xf bank_mask:0xf
  v_add_f32_dpp v14, v14, v14 row_ror:8 row_mask:0xf bank_mask:0xf
  v_add_f32_dpp v15, v15, v15 row_ror:8 row_mask:0xf bank_mask:0xf
  v_add_f32_dpp v12, v12, v12 row_ror:4 row_mask:0xf bank_mask:0xf
  v_add_f32_dpp v13, v13, v13 row_ror:4 row_mask:0xf bank_mask:0xf
  v_add_f32_dpp v14, v14, v14 row_ror:4 row_mask:0xf bank_mask:0xf
  v_add_f32_dpp v15, v15, v15 row_ror:4 row_mask:0xf bank_mask:0xf
  v_add_f32_dpp v12, v12, v12 row_ror:2 row_mask:0xf bank_mask:0xf
  v_add_f32_dpp v13, v13, v13 row_ror:2 row_mask:0xf bank_mask:0xf
  v_add_f32_dpp v14, v14, v14 row_ror:2 row_mask:0xf bank_mask:0xf
  v_add_f32_dpp v15, v15, v15 row_ror:2 row_mask:0xf bank_mask:0xf
  v_add_f32_dpp v12, v12, v12 row_ror:1 row_mask:0xf bank_mask:0xf
  v_add_f32_dpp v13, v13, v13 row_ror:1 row_mask:0xf bank_mask:0xf
  v_add_f32_dpp v14, v14, v14 row_ror:1 row_mask:0xf bank_mask:0xf
  v_add_f32_dpp v15, v15, v15 row_ror:1 row_mask:0xf bank_mask:0xf
  v_cndmask_b32 v16, v16, v12, s[96:97]
  s_lshl_b64 s[96:97], s[96:97], 1
  v_cndmask_b32 v16, v16, v13, s[96:97]
  s_lshl_b64 s[96:97], s[96:97], 1
  v_cndmask_b32 v16, v16, v14, s[96:97]
  s_lshl_b64 s[96:97], s[96:97], 1
  v_cndmask_b32 v16, v16, v15, s[96:97]
  s_lshl_b64 s[96:97], s[96:97], 1
  s_waitcnt vmcnt(4)
  v_dot2_f32_bf16 v12, v60, v8, 0
  v_dot2_f32_bf16 v13, v64, v8, 0
  v_dot2_f32_bf16 v14, v68, v8, 0
  v_dot2_f32_bf16 v15, v72, v8, 0
  v_dot2_f32_bf16 v12, v61, v9, v12
  v_dot2_f32_bf16 v13, v65, v9, v13
  v_dot2_f32_bf16 v14, v69, v9, v14
  v_dot2_f32_bf16 v15, v73, v9, v15
  v_dot2_f32_bf16 v12, v62, v10, v12
  v_dot2_f32_bf16 v13, v66, v10, v13
  v_dot2_f32_bf16 v14, v70, v10, v14
  v_dot2_f32_bf16 v15, v74, v10, v15
  v_dot2_f32_bf16 v12, v63, v11, v12
  v_dot2_f32_bf16 v13, v67, v11, v13
  v_dot2_f32_bf16 v14, v71, v11, v14
  v_dot2_f32_bf16 v15, v75, v11, v15
  v_add_f32_dpp v12, v12, v12 row_ror:8 row_mask:0xf bank_mask:0xf
  v_add_f32_dpp v13, v13, v13 row_ror:8 row_mask:0xf bank_mask:0xf
  v_add_f32_dpp v14, v14, v14 row_ror:8 row_mask:0xf bank_mask:0xf
  v_add_f32_dpp v15, v15, v15 row_ror:8 row_mask:0xf bank_mask:0xf
  v_add_f32_dpp v12, v12, v12 row_ror:4 row_mask:0xf bank_mask:0xf
  v_add_f32_dpp v13, v13, v13 row_ror:4 row_mask:0xf bank_mask:0xf
  v_add_f32_dpp v14, v14, v14 row_ror:4 row_mask:0xf bank_mask:0xf
  v_add_f32_dpp v15, v15, v15 row_ror:4 row_mask:0xf bank_mask:0xf
  v_add_f32_dpp v12, v12, v12 row_ror:2 row_mask:0xf bank_mask:0xf
  v_add_f32_dpp v13, v13, v13 row_ror:2 row_mask:0xf bank_mask:0xf
  v_add_f32_dpp v14, v14, v14 row_ror:2 row_mask:0xf bank_mask:0xf
  v_add_f32_dpp v15, v15, v15 row_ror:2 row_mask:0xf bank_mask:0xf
  v_add_f32_dpp v12, v12, v12 row_ror:1 row_mask:0xf bank_mask:0xf
  v_add_f32_dpp v13, v13, v13 row_ror:1 row_mask:0xf bank_mask:0xf
  v_add_f32_dpp v14, v14, v14 row_ror:1 row_mask:0xf bank_mask:0xf
  v_add_f32_dpp v15, v15, v15 row_ror:1 row_mask:0xf bank_mask:0xf
  v_cndmask_b32 v16, v16, v12, s[96:97]
  s_lshl_b64 s[96:97], s[96:97], 1
  v_cndmask_b32 v16, v16, v13, s[96:97]
  s_lshl_b64 s[96:97], s[96:97], 1
  v_cndmask_b32 v16, v16, v14, s[96:97]
  s_lshl_b64 s[96:97], s[96:97], 1
  v_cndmask_b32 v16, v16, v15, s[96:97]
  s_lshl_b64 s[96:97], s[96:97], 1
  s_waitcnt vmcnt(0)
  v_dot2_f32_bf16 v12, v76, v8, 0
  v_dot2_f32_bf16 v13, v80, v8, 0
  v_dot2_f32_bf16 v14, v84, v8, 0
  v_dot2_f32_bf16 v15, v88, v8, 0
  v_dot2_f32_bf16 v12, v77, v9, v12
  v_dot2_f32_bf16 v13, v81, v9, v13
  v_dot2_f32_bf16 v14, v85, v9, v14
  v_dot2_f32_bf16 v15, v89, v9, v15
  v_dot2_f32_bf16 v12, v78, v10, v12
  v_dot2_f32_bf16 v13, v82, v10, v13
  v_dot2_f32_bf16 v14, v86, v10, v14
  v_dot2_f32_bf16 v15, v90, v10, v15
  v_dot2_f32_bf16 v12, v79, v11, v12
  v_dot2_f32_bf16 v13, v83, v11, v13
  v_dot2_f32_bf16 v14, v87, v11, v14
  v_dot2_f32_bf16 v15, v91, v11, v15
  s_cmp_ge_u32 s100, 1
  s_cbranch_scc0 VD_19
  buffer_load_dwordx4 v[96:99], v4, s[44:47], s76 offen nt
  buffer_load_dwordx4 v[100:103], v4, s[44:47], s77 offen nt
  buffer_load_dwordx4 v[104:107], v4, s[44:47], s78 offen nt
  buffer_load_dwordx4 v[108:111], v4, s[44:47], s79 offen nt
  buffer_load_dwordx4 v[112:115], v4, s[44:47], s80 offen nt
  buffer_load_dwordx4 v[116:119], v4, s[44:47], s81 offen nt
  buffer_load_dwordx4 v[120:123], v4, s[44:47], s82 offen nt
  buffer_load_dwordx4 v[124:127], v4, s[44:47], s83 offen nt
VD_19:
  buffer_load_dwordx4 v[28:31], v4, s[44:47], s84 offen nt
  buffer_load_dwordx4 v[32:35], v4, s[44:47], s85 offen nt
  buffer_load_dwordx4 v[36:39], v4, s[44:47], s86 offen nt
  buffer_load_dwordx4 v[40:43], v4, s[44:47], s87 offen nt
  buffer_load_dwordx4 v[44:47], v4, s[44:47], s88 offen nt
  buffer_load_dwordx4 v[48:51], v4, s[44:47], s89 offen nt
  buffer_load_dwordx4 v[52:55], v4, s[44:47], s90 offen nt
  buffer_load_dwordx4 v[56:59], v4, s[44:47], s91 offen nt
  v_add_f32_dpp v12, v12, v12 row_ror:8 row_mask:0xf bank_mask:0xf
  v_add_f32_dpp v13, v13, v13 row_ror:8 row_mask:0xf bank_mask:0xf
  v_add_f32_dpp v14, v14, v14 row_ror:8 row_mask:0xf bank_mask:0xf
  v_add_f32_dpp v15, v15, v15 row_ror:8 row_mask:0xf bank_mask:0xf
  v_add_f32_dpp v12, v12, v12 row_ror:4 row_mask:0xf bank_mask:0xf
  v_add_f32_dpp v13, v13, v13 row_ror:4 row_mask:0xf bank_mask:0xf
  v_add_f32_dpp v14, v14, v14 row_ror:4 row_mask:0xf bank_mask:0xf
  v_add_f32_dpp v15, v15, v15 row_ror:4 row_mask:0xf bank_mask:0xf
  v_add_f32_dpp v12, v12, v12 row_ror:2 row_mask:0xf bank_mask:0xf
  v_add_f32_dpp v13, v13, v13 row_ror:2 row_mask:0xf bank_mask:0xf
  v_add_f32_dpp v14, v14, v14 row_ror:2 row_mask:0xf bank_mask:0xf
  v_add_f32_dpp v15, v15, v15 row_ror:2 row_mask:0xf bank_mask:0xf
  v_add_f32_dpp v12, v12, v12 row_ror:1 row_mask:0xf bank_mask:0xf
  v_add_f32_dpp v13, v13, v13 row_ror:1 row_mask:0xf bank_mask:0xf
  v_add_f32_dpp v14, v14, v14 row_ror:1 row_mask:0xf bank_mask:0xf
  v_add_f32_dpp v15, v15, v15 row_ror:1 row_mask:0xf bank_mask:0xf
  v_cndmask_b32 v16, v16, v12, s[96:97]
  s_lshl_b64 s[96:97], s[96:97], 1
  v_cndmask_b32 v16, v16, v13, s[96:97]
  s_lshl_b64 s[96:97], s[96:97], 1
  v_cndmask_b32 v16, v16, v14, s[96:97]
  s_lshl_b64 s[96:97], s[96:97], 1
  v_cndmask_b32 v16, v16, v15, s[96:97]
  v_cvt_pk_bf16_f32 v18, v16, v17
  v_lshlrev_b32 v16, 16, v18
  v_and_b32 v17, 0xffff0000, v18
  v_mul_f32 v16, 0x3db504f3, v16
  v_mul_f32 v17, 0x3db504f3, v17
  v_cvt_pk_bf16_f32 v18, v16, v17
  v_lshlrev_b32 v16, 16, v18
  v_and_b32 v17, 0xffff0000, v18
  v_mov_b32 v19, 0xff800000
  v_cmp_gt_u32 vcc, s93, v2
  s_nop 1
  v_cndmask_b32 v16, v19, v16, vcc
  s_cmp_gt_u32 s93, 16
  s_mov_b32 s11, 0x7f800000
  s_cselect_b32 s11, s11, 0xff800000
  v_min_f32 v17, s11, v17
  v_max_f32 v18, v16, v17
  s_nop 1
  v_max_f32_dpp v18, v18, v18 row_ror:8 row_mask:0xf bank_mask:0xf
  s_nop 1
  v_max_f32_dpp v18, v18, v18 row_ror:4 row_mask:0xf bank_mask:0xf
  s_nop 1
  v_max_f32_dpp v18, v18, v18 row_ror:2 row_mask:0xf bank_mask:0xf
  s_nop 1
  v_max_f32_dpp v18, v18, v18 row_ror:1 row_mask:0xf bank_mask:0xf
  s_nop 1
  v_max_f32_dpp v18, v18, v18 row_bcast:15 row_mask:0xa bank_mask:0xf
  s_nop 1
  v_max_f32_dpp v18, v18, v18 row_bcast:31 row_mask:0xc bank_mask:0xf
  s_nop 0
  v_readlane_b32 s11, v18, 63
  s_nop 1
  v_subrev_f32 v16, s11, v16
  v_subrev_f32 v17, s11, v17
  v_mul_f32 v16, 0x3fb8aa3b, v16
  v_mul_f32 v17, 0x3fb8aa3b, v17
  v_exp_f32 v16, v16
  v_exp_f32 v17, v17
  v_mov_b32 v18, v16
  v_fmac_f32 v18, 0x3d800000, v17
  s_nop 1
  v_add_f32_dpp v18, v18, v18 row_ror:8 row_mask:0xf bank_mask:0xf
  s_nop 1
  v_add_f32_dpp v18, v18, v18 row_ror:4 row_mask:0xf bank_mask:0xf
  s_nop 1
  v_add_f32_dpp v18, v18, v18 row_ror:2 row_mask:0xf bank_mask:0xf
  s_nop 1
  v_add_f32_dpp v18, v18, v18 row_ror:1 row_mask:0xf bank_mask:0xf
  s_nop 1
  v_add_f32_dpp v18, v18, v18 row_bcast:15 row_mask:0xa bank_mask:0xf
  s_nop 1
  v_add_f32_dpp v18, v18, v18 row_bcast:31 row_mask:0xc bank_mask:0xf
  v_mov_b32 v19, v18
  v_mov_b32 v18, s11
  s_lshl_b32 s12, s3, 3
  v_mov_b32 v5, s12
  s_mov_b32 exec_lo, 0
  s_mov_b32 exec_hi, 0x80000000
  ds_write_b64 v5, v[18:19] offset:8448
  s_waitcnt lgkmcnt(0)
  v_mov_b32 v5, 8576
  v_mov_b32 v6, 1
  ds_add_u32 v5, v6
  s_mov_b64 exec, -1
  s_add_u32 s10, s10, 1
  s_and_b32 s11, s10, 0x3ff
  v_mov_b32 v4, s11
  s_mov_b32 s76, 0xfffffc00
  v_and_b32 v6, 1, v3
  v_lshlrev_b32 v6, 1, v6
  v_lshrrev_b32 v7, 1, v3
  v_or_b32 v6, v6, v7
  v_lshl_add_u32 v19, v2, 3, v6
  v_lshlrev_b32 v19, 2, v19
  s_lshl_b32 s11, s3, 9
  v_add_u32 v19, s11, v19
  v_mov_b32 v20, 0
  v_mov_b32 v21, 0
  v_mov_b32 v22, 0
  v_mov_b32 v23, 0
  v_mov_b32 v24, 0
  v_mov_b32 v25, 0
  v_mov_b32 v26, 0
  v_mov_b32 v27, 0
  s_waitcnt vmcnt(15)
  v_lshlrev_b32 v8, 16, v96
  v_and_b32 v9, 0xffff0000, v96
  v_lshlrev_b32 v10, 16, v97
  v_and_b32 v11, 0xffff0000, v97
  v_lshlrev_b32 v12, 16, v98
  v_and_b32 v13, 0xffff0000, v98
  v_lshlrev_b32 v14, 16, v99
  v_and_b32 v15, 0xffff0000, v99
  v_fmac_f32_dpp v20, v16, v8 row_newbcast:0 row_mask:0xf bank_mask:0xf
  v_fmac_f32_dpp v21, v16, v9 row_newbcast:0 row_mask:0xf bank_mask:0xf
  v_fmac_f32_dpp v22, v16, v10 row_newbcast:0 row_mask:0xf bank_mask:0xf
  v_fmac_f32_dpp v23, v16, v11 row_newbcast:0 row_mask:0xf bank_mask:0xf
  v_fmac_f32_dpp v24, v16, v12 row_newbcast:0 row_mask:0xf bank_mask:0xf
  v_fmac_f32_dpp v25, v16, v13 row_newbcast:0 row_mask:0xf bank_mask:0xf
  v_fmac_f32_dpp v26, v16, v14 row_newbcast:0 row_mask:0xf bank_mask:0xf
  v_fmac_f32_dpp v27, v16, v15 row_newbcast:0 row_mask:0xf bank_mask:0xf
  s_waitcnt vmcnt(14)
  v_lshlrev_b32 v8, 16, v100
  v_and_b32 v9, 0xffff0000, v100
  v_lshlrev_b32 v10, 16, v101
  v_and_b32 v11, 0xffff0000, v101
  v_lshlrev_b32 v12, 16, v102
  v_and_b32 v13, 0xffff0000, v102
  v_lshlrev_b32 v14, 16, v103
  v_and_b32 v15, 0xffff0000, v103
  v_fmac_f32_dpp v20, v16, v8 row_newbcast:1 row_mask:0xf bank_mask:0xf
  v_fmac_f32_dpp v21, v16, v9 row_newbcast:1 row_mask:0xf bank_mask:0xf
  v_fmac_f32_dpp v22, v16, v10 row_newbcast:1 row_mask:0xf bank_mask:0xf
  v_fmac_f32_dpp v23, v16, v11 row_newbcast:1 row_mask:0xf bank_mask:0xf
  v_fmac_f32_dpp v24, v16, v12 row_newbcast:1 row_mask:0xf bank_mask:0xf
  v_fmac_f32_dpp v25, v16, v13 row_newbcast:1 row_mask:0xf bank_mask:0xf
  v_fmac_f32_dpp v26, v16, v14 row_newbcast:1 row_mask:0xf bank_mask:0xf
  v_fmac_f32_dpp v27, v16, v15 row_newbcast:1 row_mask:0xf bank_mask:0xf
  s_waitcnt vmcnt(13)
  v_lshlrev_b32 v8, 16, v104
  v_and_b32 v9, 0xffff0000, v104
  v_lshlrev_b32 v10, 16, v105
  v_and_b32 v11, 0xffff0000, v105
  v_lshlrev_b32 v12, 16, v106
  v_and_b32 v13, 0xffff0000, v106
  v_lshlrev_b32 v14, 16, v107
  v_and_b32 v15, 0xffff0000, v107
  v_fmac_f32_dpp v20, v16, v8 row_newbcast:2 row_mask:0xf bank_mask:0xf
  v_fmac_f32_dpp v21, v16, v9 row_newbcast:2 row_mask:0xf bank_mask:0xf
  v_fmac_f32_dpp v22, v16, v10 row_newbcast:2 row_mask:0xf bank_mask:0xf
  v_fmac_f32_dpp v23, v16, v11 row_newbcast:2 row_mask:0xf bank_mask:0xf
  v_fmac_f32_dpp v24, v16, v12 row_newbcast:2 row_mask:0xf bank_mask:0xf
  v_fmac_f32_dpp v25, v16, v13 row_newbcast:2 row_mask:0xf bank_mask:0xf
  v_fmac_f32_dpp v26, v16, v14 row_newbcast:2 row_mask:0xf bank_mask:0xf
  v_fmac_f32_dpp v27, v16, v15 row_newbcast:2 row_mask:0xf bank_mask:0xf
  s_waitcnt vmcnt(12)
  v_lshlrev_b32 v8, 16, v108
  v_and_b32 v9, 0xffff0000, v108
  v_lshlrev_b32 v10, 16, v109
  v_and_b32 v11, 0xffff0000, v109
  v_lshlrev_b32 v12, 16, v110
  v_and_b32 v13, 0xffff0000, v110
  v_lshlrev_b32 v14, 16, v111
  v_and_b32 v15, 0xffff0000, v111
  v_fmac_f32_dpp v20, v16, v8 row_newbcast:3 row_mask:0xf bank_mask:0xf
  v_fmac_f32_dpp v21, v16, v9 row_newbcast:3 row_mask:0xf bank_mask:0xf
  v_fmac_f32_dpp v22, v16, v10 row_newbcast:3 row_mask:0xf bank_mask:0xf
  v_fmac_f32_dpp v23, v16, v11 row_newbcast:3 row_mask:0xf bank_mask:0xf
  v_fmac_f32_dpp v24, v16, v12 row_newbcast:3 row_mask:0xf bank_mask:0xf
  v_fmac_f32_dpp v25, v16, v13 row_newbcast:3 row_mask:0xf bank_mask:0xf
  v_fmac_f32_dpp v26, v16, v14 row_newbcast:3 row_mask:0xf bank_mask:0xf
  v_fmac_f32_dpp v27, v16, v15 row_newbcast:3 row_mask:0xf bank_mask:0xf
  s_waitcnt vmcnt(11)
  v_lshlrev_b32 v8, 16, v112
  v_and_b32 v9, 0xffff0000, v112
  v_lshlrev_b32 v10, 16, v113
  v_and_b32 v11, 0xffff0000, v113
  v_lshlrev_b32 v12, 16, v114
  v_and_b32 v13, 0xffff0000, v114
  v_lshlrev_b32 v14, 16, v115
  v_and_b32 v15, 0xffff0000, v115
  v_fmac_f32_dpp v20, v16, v8 row_newbcast:4 row_mask:0xf bank_mask:0xf
  v_fmac_f32_dpp v21, v16, v9 row_newbcast:4 row_mask:0xf bank_mask:0xf
  v_fmac_f32_dpp v22, v16, v10 row_newbcast:4 row_mask:0xf bank_mask:0xf
  v_fmac_f32_dpp v23, v16, v11 row_newbcast:4 row_mask:0xf bank_mask:0xf
  v_fmac_f32_dpp v24, v16, v12 row_newbcast:4 row_mask:0xf bank_mask:0xf
  v_fmac_f32_dpp v25, v16, v13 row_newbcast:4 row_mask:0xf bank_mask:0xf
  v_fmac_f32_dpp v26, v16, v14 row_newbcast:4 row_mask:0xf bank_mask:0xf
  v_fmac_f32_dpp v27, v16, v15 row_newbcast:4 row_mask:0xf bank_mask:0xf
  s_waitcnt vmcnt(10)
  v_lshlrev_b32 v8, 16, v116
  v_and_b32 v9, 0xffff0000, v116
  v_lshlrev_b32 v10, 16, v117
  v_and_b32 v11, 0xffff0000, v117
  v_lshlrev_b32 v12, 16, v118
  v_and_b32 v13, 0xffff0000, v118
  v_lshlrev_b32 v14, 16, v119
  v_and_b32 v15, 0xffff0000, v119
  v_fmac_f32_dpp v20, v16, v8 row_newbcast:5 row_mask:0xf bank_mask:0xf
  v_fmac_f32_dpp v21, v16, v9 row_newbcast:5 row_mask:0xf bank_mask:0xf
  v_fmac_f32_dpp v22, v16, v10 row_newbcast:5 row_mask:0xf bank_mask:0xf
  v_fmac_f32_dpp v23, v16, v11 row_newbcast:5 row_mask:0xf bank_mask:0xf
  v_fmac_f32_dpp v24, v16, v12 row_newbcast:5 row_mask:0xf bank_mask:0xf
  v_fmac_f32_dpp v25, v16, v13 row_newbcast:5 row_mask:0xf bank_mask:0xf
  v_fmac_f32_dpp v26, v16, v14 row_newbcast:5 row_mask:0xf bank_mask:0xf
  v_fmac_f32_dpp v27, v16, v15 row_newbcast:5 row_mask:0xf bank_mask:0xf
  s_waitcnt vmcnt(9)
  v_lshlrev_b32 v8, 16, v120
  v_and_b32 v9, 0xffff0000, v120
  v_lshlrev_b32 v10, 16, v121
  v_and_b32 v11, 0xffff0000, v121
  v_lshlrev_b32 v12, 16, v122
  v_and_b32 v13, 0xffff0000, v122
  v_lshlrev_b32 v14, 16, v123
  v_and_b32 v15, 0xffff0000, v123
  v_fmac_f32_dpp v20, v16, v8 row_newbcast:6 row_mask:0xf bank_mask:0xf
  v_fmac_f32_dpp v21, v16, v9 row_newbcast:6 row_mask:0xf bank_mask:0xf
  v_fmac_f32_dpp v22, v16, v10 row_newbcast:6 row_mask:0xf bank_mask:0xf
  v_fmac_f32_dpp v23, v16, v11 row_newbcast:6 row_mask:0xf bank_mask:0xf
  v_fmac_f32_dpp v24, v16, v12 row_newbcast:6 row_mask:0xf bank_mask:0xf
  v_fmac_f32_dpp v25, v16, v13 row_newbcast:6 row_mask:0xf bank_mask:0xf
  v_fmac_f32_dpp v26, v16, v14 row_newbcast:6 row_mask:0xf bank_mask:0xf
  v_fmac_f32_dpp v27, v16, v15 row_newbcast:6 row_mask:0xf bank_mask:0xf
  s_waitcnt vmcnt(8)
  v_lshlrev_b32 v8, 16, v124
  v_and_b32 v9, 0xffff0000, v124
  v_lshlrev_b32 v10, 16, v125
  v_and_b32 v11, 0xffff0000, v125
  v_lshlrev_b32 v12, 16, v126
  v_and_b32 v13, 0xffff0000, v126
  v_lshlrev_b32 v14, 16, v127
  v_and_b32 v15, 0xffff0000, v127
  v_fmac_f32_dpp v20, v16, v8 row_newbcast:7 row_mask:0xf bank_mask:0xf
  v_fmac_f32_dpp v21, v16, v9 row_newbcast:7 row_mask:0xf bank_mask:0xf
  v_fmac_f32_dpp v22, v16, v10 row_newbcast:7 row_mask:0xf bank_mask:0xf
  v_fmac_f32_dpp v23, v16, v11 row_newbcast:7 row_mask:0xf bank_mask:0xf
  v_fmac_f32_dpp v24, v16, v12 row_newbcast:7 row_mask:0xf bank_mask:0xf
  v_fmac_f32_dpp v25, v16, v13 row_newbcast:7 row_mask:0xf bank_mask:0xf
  v_fmac_f32_dpp v26, v16, v14 row_newbcast:7 row_mask:0xf bank_mask:0xf
  v_fmac_f32_dpp v27, v16, v15 row_newbcast:7 row_mask:0xf bank_mask:0xf
  s_waitcnt vmcnt(7)
  v_lshlrev_b32 v8, 16, v28
  v_and_b32 v9, 0xffff0000, v28
  v_lshlrev_b32 v10, 16, v29
  v_and_b32 v11, 0xffff0000, v29
  v_lshlrev_b32 v12, 16, v30
  v_and_b32 v13, 0xffff0000, v30
  v_lshlrev_b32 v14, 16, v31
  v_and_b32 v15, 0xffff0000, v31
  v_fmac_f32_dpp v20, v16, v8 row_newbcast:8 row_mask:0xf bank_mask:0xf
  v_fmac_f32_dpp v21, v16, v9 row_newbcast:8 row_mask:0xf bank_mask:0xf
  v_fmac_f32_dpp v22, v16, v10 row_newbcast:8 row_mask:0xf bank_mask:0xf
  v_fmac_f32_dpp v23, v16, v11 row_newbcast:8 row_mask:0xf bank_mask:0xf
  v_fmac_f32_dpp v24, v16, v12 row_newbcast:8 row_mask:0xf bank_mask:0xf
  v_fmac_f32_dpp v25, v16, v13 row_newbcast:8 row_mask:0xf bank_mask:0xf
  v_fmac_f32_dpp v26, v16, v14 row_newbcast:8 row_mask:0xf bank_mask:0xf
  v_fmac_f32_dpp v27, v16, v15 row_newbcast:8 row_mask:0xf bank_mask:0xf
  s_waitcnt vmcnt(6)
  v_lshlrev_b32 v8, 16, v32
  v_and_b32 v9, 0xffff0000, v32
  v_lshlrev_b32 v10, 16, v33
  v_and_b32 v11, 0xffff0000, v33
  v_lshlrev_b32 v12, 16, v34
  v_and_b32 v13, 0xffff0000, v34
  v_lshlrev_b32 v14, 16, v35
  v_and_b32 v15, 0xffff0000, v35
  v_fmac_f32_dpp v20, v16, v8 row_newbcast:9 row_mask:0xf bank_mask:0xf
  v_fmac_f32_dpp v21, v16, v9 row_newbcast:9 row_mask:0xf bank_mask:0xf
  v_fmac_f32_dpp v22, v16, v10 row_newbcast:9 row_mask:0xf bank_mask:0xf
  v_fmac_f32_dpp v23, v16, v11 row_newbcast:9 row_mask:0xf bank_mask:0xf
  v_fmac_f32_dpp v24, v16, v12 row_newbcast:9 row_mask:0xf bank_mask:0xf
  v_fmac_f32_dpp v25, v16, v13 row_newbcast:9 row_mask:0xf bank_mask:0xf
  v_fmac_f32_dpp v26, v16, v14 row_newbcast:9 row_mask:0xf bank_mask:0xf
  v_fmac_f32_dpp v27, v16, v15 row_newbcast:9 row_mask:0xf bank_mask:0xf
  s_waitcnt vmcnt(5)
  v_lshlrev_b32 v8, 16, v36
  v_and_b32 v9, 0xffff0000, v36
  v_lshlrev_b32 v10, 16, v37
  v_and_b32 v11, 0xffff0000, v37
  v_lshlrev_b32 v12, 16, v38
  v_and_b32 v13, 0xffff0000, v38
  v_lshlrev_b32 v14, 16, v39
  v_and_b32 v15, 0xffff0000, v39
  v_fmac_f32_dpp v20, v16, v8 row_newbcast:10 row_mask:0xf bank_mask:0xf
  v_fmac_f32_dpp v21, v16, v9 row_newbcast:10 row_mask:0xf bank_mask:0xf
  v_fmac_f32_dpp v22, v16, v10 row_newbcast:10 row_mask:0xf bank_mask:0xf
  v_fmac_f32_dpp v23, v16, v11 row_newbcast:10 row_mask:0xf bank_mask:0xf
  v_fmac_f32_dpp v24, v16, v12 row_newbcast:10 row_mask:0xf bank_mask:0xf
  v_fmac_f32_dpp v25, v16, v13 row_newbcast:10 row_mask:0xf bank_mask:0xf
  v_fmac_f32_dpp v26, v16, v14 row_newbcast:10 row_mask:0xf bank_mask:0xf
  v_fmac_f32_dpp v27, v16, v15 row_newbcast:10 row_mask:0xf bank_mask:0xf
  s_waitcnt vmcnt(4)
  v_lshlrev_b32 v8, 16, v40
  v_and_b32 v9, 0xffff0000, v40
  v_lshlrev_b32 v10, 16, v41
  v_and_b32 v11, 0xffff0000, v41
  v_lshlrev_b32 v12, 16, v42
  v_and_b32 v13, 0xffff0000, v42
  v_lshlrev_b32 v14, 16, v43
  v_and_b32 v15, 0xffff0000, v43
  v_fmac_f32_dpp v20, v16, v8 row_newbcast:11 row_mask:0xf bank_mask:0xf
  v_fmac_f32_dpp v21, v16, v9 row_newbcast:11 row_mask:0xf bank_mask:0xf
  v_fmac_f32_dpp v22, v16, v10 row_newbcast:11 row_mask:0xf bank_mask:0xf
  v_fmac_f32_dpp v23, v16, v11 row_newbcast:11 row_mask:0xf bank_mask:0xf
  v_fmac_f32_dpp v24, v16, v12 row_newbcast:11 row_mask:0xf bank_mask:0xf
  v_fmac_f32_dpp v25, v16, v13 row_newbcast:11 row_mask:0xf bank_mask:0xf
  v_fmac_f32_dpp v26, v16, v14 row_newbcast:11 row_mask:0xf bank_mask:0xf
  v_fmac_f32_dpp v27, v16, v15 row_newbcast:11 row_mask:0xf bank_mask:0xf
  s_waitcnt vmcnt(3)
  v_lshlrev_b32 v8, 16, v44
  v_and_b32 v9, 0xffff0000, v44
  v_lshlrev_b32 v10, 16, v45
  v_and_b32 v11, 0xffff0000, v45
  v_lshlrev_b32 v12, 16, v46
  v_and_b32 v13, 0xffff0000, v46
  v_lshlrev_b32 v14, 16, v47
  v_and_b32 v15, 0xffff0000, v47
  v_fmac_f32_dpp v20, v16, v8 row_newbcast:12 row_mask:0xf bank_mask:0xf
  v_fmac_f32_dpp v21, v16, v9 row_newbcast:12 row_mask:0xf bank_mask:0xf
  v_fmac_f32_dpp v22, v16, v10 row_newbcast:12 row_mask:0xf bank_mask:0xf
  v_fmac_f32_dpp v23, v16, v11 row_newbcast:12 row_mask:0xf bank_mask:0xf
  v_fmac_f32_dpp v24, v16, v12 row_newbcast:12 row_mask:0xf bank_mask:0xf
  v_fmac_f32_dpp v25, v16, v13 row_newbcast:12 row_mask:0xf bank_mask:0xf
  v_fmac_f32_dpp v26, v16, v14 row_newbcast:12 row_mask:0xf bank_mask:0xf
  v_fmac_f32_dpp v27, v16, v15 row_newbcast:12 row_mask:0xf bank_mask:0xf
  s_waitcnt vmcnt(2)
  v_lshlrev_b32 v8, 16, v48
  v_and_b32 v9, 0xffff0000, v48
  v_lshlrev_b32 v10, 16, v49
  v_and_b32 v11, 0xffff0000, v49
  v_lshlrev_b32 v12, 16, v50
  v_and_b32 v13, 0xffff0000, v50
  v_lshlrev_b32 v14, 16, v51
  v_and_b32 v15, 0xffff0000, v51
  v_fmac_f32_dpp v20, v16, v8 row_newbcast:13 row_mask:0xf bank_mask:0xf
  v_fmac_f32_dpp v21, v16, v9 row_newbcast:13 row_mask:0xf bank_mask:0xf
  v_fmac_f32_dpp v22, v16, v10 row_newbcast:13 row_mask:0xf bank_mask:0xf
  v_fmac_f32_dpp v23, v16, v11 row_newbcast:13 row_mask:0xf bank_mask:0xf
  v_fmac_f32_dpp v24, v16, v12 row_newbcast:13 row_mask:0xf bank_mask:0xf
  v_fmac_f32_dpp v25, v16, v13 row_newbcast:13 row_mask:0xf bank_mask:0xf
  v_fmac_f32_dpp v26, v16, v14 row_newbcast:13 row_mask:0xf bank_mask:0xf
  v_fmac_f32_dpp v27, v16, v15 row_newbcast:13 row_mask:0xf bank_mask:0xf
  s_waitcnt vmcnt(1)
  v_lshlrev_b32 v8, 16, v52
  v_and_b32 v9, 0xffff0000, v52
  v_lshlrev_b32 v10, 16, v53
  v_and_b32 v11, 0xffff0000, v53
  v_lshlrev_b32 v12, 16, v54
  v_and_b32 v13, 0xffff0000, v54
  v_lshlrev_b32 v14, 16, v55
  v_and_b32 v15, 0xffff0000, v55
  v_fmac_f32_dpp v20, v16, v8 row_newbcast:14 row_mask:0xf bank_mask:0xf
  v_fmac_f32_dpp v21, v16, v9 row_newbcast:14 row_mask:0xf bank_mask:0xf
  v_fmac_f32_dpp v22, v16, v10 row_newbcast:14 row_mask:0xf bank_mask:0xf
  v_fmac_f32_dpp v23, v16, v11 row_newbcast:14 row_mask:0xf bank_mask:0xf
  v_fmac_f32_dpp v24, v16, v12 row_newbcast:14 row_mask:0xf bank_mask:0xf
  v_fmac_f32_dpp v25, v16, v13 row_newbcast:14 row_mask:0xf bank_mask:0xf
  v_fmac_f32_dpp v26, v16, v14 row_newbcast:14 row_mask:0xf bank_mask:0xf
  v_fmac_f32_dpp v27, v16, v15 row_newbcast:14 row_mask:0xf bank_mask:0xf
  s_waitcnt vmcnt(0)
  v_lshlrev_b32 v8, 16, v56
  v_and_b32 v9, 0xffff0000, v56
  v_lshlrev_b32 v10, 16, v57
  v_and_b32 v11, 0xffff0000, v57
  v_lshlrev_b32 v12, 16, v58
  v_and_b32 v13, 0xffff0000, v58
  v_lshlrev_b32 v14, 16, v59
  v_and_b32 v15, 0xffff0000, v59
  v_fmac_f32_dpp v20, v16, v8 row_newbcast:15 row_mask:0xf bank_mask:0xf
  v_fmac_f32_dpp v21, v16, v9 row_newbcast:15 row_mask:0xf bank_mask:0xf
  v_fmac_f32_dpp v22, v16, v10 row_newbcast:15 row_mask:0xf bank_mask:0xf
  v_fmac_f32_dpp v23, v16, v11 row_newbcast:15 row_mask:0xf bank_mask:0xf
  v_fmac_f32_dpp v24, v16, v12 row_newbcast:15 row_mask:0xf bank_mask:0xf
  v_fmac_f32_dpp v25, v16, v13 row_newbcast:15 row_mask:0xf bank_mask:0xf
  v_fmac_f32_dpp v26, v16, v14 row_newbcast:15 row_mask:0xf bank_mask:0xf
  v_fmac_f32_dpp v27, v16, v15 row_newbcast:15 row_mask:0xf bank_mask:0xf
  v_permlane32_swap_b32 v20, v21
  v_permlane32_swap_b32 v22, v23
  v_permlane32_swap_b32 v24, v25
  v_permlane32_swap_b32 v26, v27
  v_add_f32 v20, v20, v21
  v_add_f32 v22, v22, v23
  v_add_f32 v24, v24, v25
  v_add_f32 v26, v26, v27
  v_permlane16_swap_b32 v20, v22
  s_nop 0
  v_permlane16_swap_b32 v24, v26
  v_add_f32 v8, v20, v22
  v_add_f32 v9, v24, v26
  ds_write_b32 v19, v8 offset:0
  ds_write_b32 v19, v9 offset:16
  s_cmp_lt_u32 s3, 16
  s_cbranch_scc0 WSP_22
  s_cmp_eq_u32 s27, 1
  s_cbranch_scc0 NWD_23
  s_lshl_b32 s13, s3, 12
  v_lshlrev_b32 v5, 4, v1
  s_mul_i32 s12, s3, 4224
  s_add_u32 s12, s12, 20480
  s_mov_b32 m0, s12
  s_nop 0
  buffer_load_dwordx4 v5, s[60:63], s13 offen nt lds
  s_add_u32 s12, s12, 1056
  s_add_u32 s13, s13, 1024
  s_mov_b32 m0, s12
  s_nop 0
  buffer_load_dwordx4 v5, s[60:63], s13 offen nt lds
  s_add_u32 s12, s12, 1056
  s_add_u32 s13, s13, 1024
  s_mov_b32 m0, s12
  s_nop 0
  buffer_load_dwordx4 v5, s[60:63], s13 offen nt lds
  s_add_u32 s12, s12, 1056
  s_add_u32 s13, s13, 1024
  s_mov_b32 m0, s12
  s_nop 0
  buffer_load_dwordx4 v5, s[60:63], s13 offen nt lds
NWD_23:
WSP_22:
  s_cmp_lt_u32 s3, 4
  s_cbranch_scc0 W4_24
  v_mov_b32 v6, 8576
LW_25:
  ds_read_b32 v7, v6
  s_waitcnt lgkmcnt(0)
  v_readfirstlane_b32 s15, v7
  s_nop 0
  s_cmp_ge_u32 s15, 16
  s_cbranch_scc1 LWOK_26
  s_sleep 1
  s_branch LW_25
LWOK_26:
  v_lshrrev_b32 v7, 3, v1
  v_lshlrev_b32 v13, 4, v7
  ds_read_b128 v[12:15], v13 offset:8448
  s_waitcnt lgkmcnt(0)
  v_max_f32 v16, v12, v14
  s_nop 1
  v_max_f32_dpp v16, v16, v16 row_ror:8 row_mask:0xf bank_mask:0xf
  s_nop 1
  v_max_f32_dpp v16, v16, v16 row_ror:4 row_mask:0xf bank_mask:0xf
  s_nop 1
  v_max_f32_dpp v16, v16, v16 row_ror:2 row_mask:0xf bank_mask:0xf
  s_nop 1
  v_max_f32_dpp v16, v16, v16 row_ror:1 row_mask:0xf bank_mask:0xf
  s_nop 1
  v_max_f32_dpp v16, v16, v16 row_bcast:15 row_mask:0xa bank_mask:0xf
  s_nop 1
  v_max_f32_dpp v16, v16, v16 row_bcast:31 row_mask:0xc bank_mask:0xf
  s_nop 0
  v_readlane_b32 s11, v16, 63
  s_nop 1
  v_subrev_f32 v12, s11, v12
  v_subrev_f32 v14, s11, v14
  v_mul_f32 v12, 0x3fb8aa3b, v12
  v_mul_f32 v14, 0x3fb8aa3b, v14
  v_exp_f32 v12, v12
  v_exp_f32 v14, v14
  v_mul_f32 v16, v12, v13
  v_fmac_f32 v16, v14, v15
  v_mul_f32 v16, 0x3e000000, v16
  s_nop 1
  v_add_f32_dpp v16, v16, v16 row_ror:8 row_mask:0xf bank_mask:0xf
  s_nop 1
  v_add_f32_dpp v16, v16, v16 row_ror:4 row_mask:0xf bank_mask:0xf
  s_nop 1
  v_add_f32_dpp v16, v16, v16 row_ror:2 row_mask:0xf bank_mask:0xf
  s_nop 1
  v_add_f32_dpp v16, v16, v16 row_ror:1 row_mask:0xf bank_mask:0xf
  s_nop 1
  v_add_f32_dpp v16, v16, v16 row_bcast:15 row_mask:0xa bank_mask:0xf
  s_nop 1
  v_add_f32_dpp v16, v16, v16 row_bcast:31 row_mask:0xc bank_mask:0xf
  s_cmp_eq_u32 s3, 0
  s_cbranch_scc0 NOML_27
  v_mov_b32 v17, v16
  v_mov_b32 v16, s11
  v_and_or_b32 v16, v16, s76, v4
  v_and_or_b32 v17, v17, s76, v4
  s_lshl_b32 s12, s6, 2
  s_add_u32 s12, s12, s9
  s_lshl_b32 s12, s12, 3
  s_add_u32 s12, s12, 0x40000
  v_mov_b32 v5, 0
  s_mov_b32 exec_lo, 0
  s_mov_b32 exec_hi, 0x80000000
  buffer_store_dwordx2 v[16:17], v5, s[48:51], s12 offen sc1
  s_mov_b64 exec, -1
NOML_27:
  v_and_b32 v5, 7, v1
  v_lshlrev_b32 v16, 4, v5
  v_lshrrev_b32 v7, 3, v1
  v_lshlrev_b32 v6, 10, v7
  v_add_u32 v16, v16, v6
  s_lshl_b32 s11, s3, 7
  v_add_u32 v16, s11, v16
  v_and_b32 v6, 1, v3
  v_lshlrev_b32 v6, 1, v6
  v_lshrrev_b32 v7, 1, v3
  v_or_b32 v6, v6, v7
  v_lshl_add_u32 v17, v5, 2, v6
  v_lshlrev_b32 v17, 2, v17
  s_lshl_b32 s98, s6, 2
  s_add_u32 s98, s98, s9
  s_lshl_b32 s98, s98, 9
  s_add_u32 s98, s98, s11
  s_add_u32 s98, s98, 0x50000
W4_24:
  s_waitcnt lgkmcnt(0)
  s_barrier
  s_cmp_lt_u32 s3, 4
  s_cbranch_scc0 XW_28
  ds_read_b128 v[20:23], v16 offset:0
  ds_read_b128 v[24:27], v16 offset:512
  s_waitcnt lgkmcnt(0)
  v_mul_f32 v20, v20, v12
  v_mul_f32 v21, v21, v12
  v_mul_f32 v22, v22, v12
  v_mul_f32 v23, v23, v12
  v_fmac_f32 v20, v24, v14
  v_fmac_f32 v21, v25, v14
  v_fmac_f32 v22, v26, v14
  v_fmac_f32 v23, v27, v14
  v_permlane32_swap_b32 v20, v21
  s_nop 0
  v_permlane32_swap_b32 v22, v23
  v_add_f32 v20, v20, v21
  v_add_f32 v22, v22, v23
  s_nop 1
  v_permlane16_swap_b32 v20, v22
  v_add_f32 v20, v20, v22
  s_nop 1
  v_add_f32_dpp v20, v20, v20 row_ror:8 row_mask:0xf bank_mask:0xf
  v_and_or_b32 v20, v20, s76, v4
  s_mov_b32 exec_lo, 0x00ff00ff
  s_mov_b32 exec_hi, 0x00ff00ff
  buffer_store_dword v20, v17, s[48:51], s98 offen sc1
  s_mov_b64 exec, -1
  s_cmp_eq_u32 s27, 2
  s_cbranch_scc0 NFD_29
  s_lshl_b32 s11, s3, 5
  v_lshrrev_b32 v5, 2, v1
  v_add_u32 v5, s11, v5
  s_movk_i32 s12, 2752
  v_mul_lo_u32 v5, v5, s12
  v_and_b32 v6, 3, v1
  v_lshl_add_u32 v5, v6, 4, v5
  s_lshl_b32 s11, s3, 11
  s_add_u32 s12, s11, 20480
  s_mov_b32 m0, s12
  s_nop 0
  buffer_load_dwordx4 v5, s[60:63], 0 offen lds
  s_add_u32 s12, s12, 1024
  s_mov_b32 s13, 44032
  s_mov_b32 m0, s12
  s_nop 0
  buffer_load_dwordx4 v5, s[60:63], s13 offen lds
  v_lshlrev_b32 v6, 4, v1
  v_add_u32 v6, s11, v6
  s_mul_i32 s12, s3, 2112
  s_add_u32 s12, s12, 53248
  s_mov_b32 m0, s12
  s_nop 0
  buffer_load_dwordx4 v6, s[64:67], 0 offen nt lds
  s_add_u32 s12, s12, 1056
  s_movk_i32 s13, 1024
  s_mov_b32 m0, s12
  s_nop 0
  buffer_load_dwordx4 v6, s[64:67], s13 offen nt lds
NFD_29:
  s_cmp_eq_u32 s27, 0
  s_cbranch_scc1 L_FIN
  s_cmp_eq_u32 s27, 3
  s_cbranch_scc1 RED_31
  s_cmp_eq_u32 s27, 1
  s_cbranch_scc0 FFN_30
  v_bfe_u32 v10, v2, 2, 1
  v_and_b32 v11, 3, v2
  v_lshlrev_b32 v40, 10, v10
  v_lshl_add_u32 v41, v11, 3, v40
  s_lshl_b32 s98, s101, 5
  s_add_u32 s98, s98, 0x40000
  v_lshlrev_b32 v42, 16, v10
  v_lshl_add_u32 v42, v11, 9, v42
  v_lshl_add_u32 v42, v3, 5, v42
  s_lshl_b32 s99, s101, 11
  s_and_b32 s12, s95, 1
  s_lshl_b32 s12, s12, 8
  s_add_u32 s99, s99, s12
  s_add_u32 s99, s99, 0x50000
  buffer_load_dwordx4 v[44:47], v42, s[48:51], s99 offen offset:0 sc1
  buffer_load_dwordx4 v[48:51], v42, s[48:51], s99 offen offset:16 sc1
  buffer_load_dwordx4 v[52:55], v42, s[48:51], s99 offen offset:128 sc1
  buffer_load_dwordx4 v[56:59], v42, s[48:51], s99 offen offset:144 sc1
  buffer_load_dwordx4 v[12:15], v40, s[48:51], s98 offen sc1
  buffer_load_dwordx4 v[16:19], v40, s[48:51], s98 offen offset:16 sc1
  buffer_load_dwordx2 v[20:21], v41, s[48:51], s98 offen sc1
  v_lshrrev_b32 v8, 2, v2
  v_and_b32 v9, 3, v2
  v_lshl_add_u32 v5, v3, 3, v8
  s_movk_i32 s11, 1056
  v_mul_lo_u32 v5, v5, s11
  v_lshl_add_u32 v5, v9, 3, v5
  s_lshl_b32 s11, s3, 8
  v_add_u32 v5, s11, v5
  v_add_u32 v5, 20480, v5
  s_waitcnt vmcnt(7)
  s_barrier
  ds_read_b64_tr_b16 v[64:65], v5 offset:0
  ds_read_b64_tr_b16 v[66:67], v5 offset:4224
  ds_read_b64_tr_b16 v[68:69], v5 offset:32
  ds_read_b64_tr_b16 v[70:71], v5 offset:4256
  ds_read_b64_tr_b16 v[72:73], v5 offset:64
  ds_read_b64_tr_b16 v[74:75], v5 offset:4288
  ds_read_b64_tr_b16 v[76:77], v5 offset:96
  ds_read_b64_tr_b16 v[78:79], v5 offset:4320
  ds_read_b64_tr_b16 v[80:81], v5 offset:128
  ds_read_b64_tr_b16 v[82:83], v5 offset:4352
  ds_read_b64_tr_b16 v[84:85], v5 offset:160
  ds_read_b64_tr_b16 v[86:87], v5 offset:4384
  ds_read_b64_tr_b16 v[88:89], v5 offset:192
  ds_read_b64_tr_b16 v[90:91], v5 offset:4416
  ds_read_b64_tr_b16 v[92:93], v5 offset:224
  ds_read_b64_tr_b16 v[94:95], v5 offset:4448
  ds_read_b64_tr_b16 v[96:97], v5 offset:33792
  ds_read_b64_tr_b16 v[98:99], v5 offset:38016
  ds_read_b64_tr_b16 v[100:101], v5 offset:33824
  ds_read_b64_tr_b16 v[102:103], v5 offset:38048
  ds_read_b64_tr_b16 v[104:105], v5 offset:33856
  ds_read_b64_tr_b16 v[106:107], v5 offset:38080
  ds_read_b64_tr_b16 v[108:109], v5 offset:33888
  ds_read_b64_tr_b16 v[110:111], v5 offset:38112
  ds_read_b64_tr_b16 v[112:113], v5 offset:33920
  ds_read_b64_tr_b16 v[114:115], v5 offset:38144
  ds_read_b64_tr_b16 v[116:117], v5 offset:33952
  ds_read_b64_tr_b16 v[118:119], v5 offset:38176
  ds_read_b64_tr_b16 v[120:121], v5 offset:33984
  ds_read_b64_tr_b16 v[122:123], v5 offset:38208
  ds_read_b64_tr_b16 v[124:125], v5 offset:34016
  ds_read_b64_tr_b16 v[126:127], v5 offset:38240
  v_and_b32 v43, 1, v3
  v_lshlrev_b32 v43, 17, v43
  v_lshrrev_b32 v6, 1, v3
  v_lshlrev_b32 v6, 12, v6
  v_add_u32 v43, v43, v6
  v_lshl_add_u32 v43, v2, 2, v43
  s_lshl_b32 s100, s3, 15
  s_lshl_b32 s12, s95, 6
  s_add_u32 s100, s100, s12
  s_add_u32 s100, s100, 0x80000
  s_mov_b32 s96, 0
  s_mov_b32 s97, -1
  s_mov_b32 s94, 400000
  s_branch PF_33
PA_32:
  buffer_load_dwordx4 v[44:47], v42, s[48:51], s99 offen offset:0 sc1
  buffer_load_dwordx4 v[48:51], v42, s[48:51], s99 offen offset:16 sc1
  buffer_load_dwordx4 v[52:55], v42, s[48:51], s99 offen offset:128 sc1
  buffer_load_dwordx4 v[56:59], v42, s[48:51], s99 offen offset:144 sc1
  buffer_load_dwordx4 v[12:15], v40, s[48:51], s98 offen sc1
  buffer_load_dwordx4 v[16:19], v40, s[48:51], s98 offen offset:16 sc1
  buffer_load_dwordx2 v[20:21], v41, s[48:51], s98 offen sc1
PF_33:
  s_waitcnt vmcnt(0)
  v_xor_b32 v12, v4, v12
  v_xor_b32 v13, v4, v13
  v_xor_b32 v14, v4, v14
  v_xor_b32 v15, v4, v15
  v_xor_b32 v16, v4, v16
  v_xor_b32 v17, v4, v17
  v_xor_b32 v18, v4, v18
  v_xor_b32 v19, v4, v19
  v_xor_b32 v20, v4, v20
  v_xor_b32 v21, v4, v21
  v_or3_b32 v7, v12, v13, v14
  v_or3_b32 v7, v7, v15, v16
  v_or3_b32 v7, v7, v17, v18
  v_or3_b32 v7, v7, v19, v20
  v_or_b32 v7, v7, v21
  v_and_b32 v7, 0x3ff, v7
  v_cmp_ne_u32 vcc, 0, v7
  s_cbranch_vccz PB_37
  s_sub_u32 s94, s94, 1
  s_cbranch_scc0 PA_32
PB_37:
  v_max3_f32 v22, v12, v14, v16
  v_max_f32 v22, v22, v18
  v_sub_f32 v23, v12, v22
  v_sub_f32 v24, v14, v22
  v_sub_f32 v25, v16, v22
  v_sub_f32 v26, v18, v22
  v_sub_f32 v27, v20, v22
  v_mul_f32 v23, 0x3fb8aa3b, v23
  v_mul_f32 v24, 0x3fb8aa3b, v24
  v_mul_f32 v25, 0x3fb8aa3b, v25
  v_mul_f32 v26, 0x3fb8aa3b, v26
  v_mul_f32 v27, 0x3fb8aa3b, v27
  v_exp_f32 v23, v23
  v_exp_f32 v24, v24
  v_exp_f32 v25, v25
  v_exp_f32 v26, v26
  v_exp_f32 v27, v27
  v_mul_f32 v22, v23, v13
  v_fmac_f32 v22, v24, v15
  v_fmac_f32 v22, v25, v17
  v_fmac_f32 v22, v26, v19
  v_rcp_f32 v22, v22
  s_nop 0
  v_mul_f32 v22, v22, v27
  s_branch PC_34
PO_35:
  buffer_load_dwordx4 v[44:47], v42, s[48:51], s99 offen offset:0 sc1
  buffer_load_dwordx4 v[48:51], v42, s[48:51], s99 offen offset:16 sc1
  buffer_load_dwordx4 v[52:55], v42, s[48:51], s99 offen offset:128 sc1
  buffer_load_dwordx4 v[56:59], v42, s[48:51], s99 offen offset:144 sc1
  s_waitcnt vmcnt(0)
PC_34:
  v_xor_b32 v44, v4, v44
  v_xor_b32 v45, v4, v45
  v_xor_b32 v46, v4, v46
  v_xor_b32 v47, v4, v47
  v_xor_b32 v48, v4, v48
  v_xor_b32 v49, v4, v49
  v_xor_b32 v50, v4, v50
  v_xor_b32 v51, v4, v51
  v_xor_b32 v52, v4, v52
  v_xor_b32 v53, v4, v53
  v_xor_b32 v54, v4, v54
  v_xor_b32 v55, v4, v55
  v_xor_b32 v56, v4, v56
  v_xor_b32 v57, v4, v57
  v_xor_b32 v58, v4, v58
  v_xor_b32 v59, v4, v59
  v_or3_b32 v7, v44, v45, v46
  v_or3_b32 v7, v7, v47, v48
  v_or3_b32 v7, v7, v49, v50
  v_or3_b32 v7, v7, v51, v52
  v_or3_b32 v7, v7, v53, v54
  v_or3_b32 v7, v7, v55, v56
  v_or3_b32 v7, v7, v57, v58
  v_or_b32 v7, v7, v59
  v_and_b32 v7, 0x3ff, v7
  v_cmp_ne_u32 vcc, 0, v7
  s_cbranch_vccz POK_36
  s_sub_u32 s94, s94, 1
  s_cbranch_scc0 PO_35
POK_36:
  v_mul_f32 v44, v44, v22
  v_mul_f32 v45, v45, v22
  v_mul_f32 v46, v46, v22
  v_mul_f32 v47, v47, v22
  v_mul_f32 v48, v48, v22
  v_mul_f32 v49, v49, v22
  v_mul_f32 v50, v50, v22
  v_mul_f32 v51, v51, v22
  v_mul_f32 v52, v52, v22
  v_mul_f32 v53, v53, v22
  v_mul_f32 v54, v54, v22
  v_mul_f32 v55, v55, v22
  v_mul_f32 v56, v56, v22
  v_mul_f32 v57, v57, v22
  v_mul_f32 v58, v58, v22
  v_mul_f32 v59, v59, v22
  v_add_f32_dpp v44, v44, v44 quad_perm:[1,0,3,2] row_mask:0xf bank_mask:0xf
  v_add_f32_dpp v45, v45, v45 quad_perm:[1,0,3,2] row_mask:0xf bank_mask:0xf
  v_add_f32_dpp v46, v46, v46 quad_perm:[1,0,3,2] row_mask:0xf bank_mask:0xf
  v_add_f32_dpp v47, v47, v47 quad_perm:[1,0,3,2] row_mask:0xf bank_mask:0xf
  v_add_f32_dpp v48, v48, v48 quad_perm:[1,0,3,2] row_mask:0xf bank_mask:0xf
  v_add_f32_dpp v49, v49, v49 quad_perm:[1,0,3,2] row_mask:0xf bank_mask:0xf
  v_add_f32_dpp v50, v50, v50 quad_perm:[1,0,3,2] row_mask:0xf bank_mask:0xf
  v_add_f32_dpp v51, v51, v51 quad_perm:[1,0,3,2] row_mask:0xf bank_mask:0xf
  v_add_f32_dpp v52, v52, v52 quad_perm:[1,0,3,2] row_mask:0xf bank_mask:0xf
  v_add_f32_dpp v53, v53, v53 quad_perm:[1,0,3,2] row_mask:0xf bank_mask:0xf
  v_add_f32_dpp v54, v54, v54 quad_perm:[1,0,3,2] row_mask:0xf bank_mask:0xf
  v_add_f32_dpp v55, v55, v55 quad_perm:[1,0,3,2] row_mask:0xf bank_mask:0xf
  v_add_f32_dpp v56, v56, v56 quad_perm:[1,0,3,2] row_mask:0xf bank_mask:0xf
  v_add_f32_dpp v57, v57, v57 quad_perm:[1,0,3,2] row_mask:0xf bank_mask:0xf
  v_add_f32_dpp v58, v58, v58 quad_perm:[1,0,3,2] row_mask:0xf bank_mask:0xf
  v_add_f32_dpp v59, v59, v59 quad_perm:[1,0,3,2] row_mask:0xf bank_mask:0xf
  v_add_f32_dpp v44, v44, v44 quad_perm:[2,3,0,1] row_mask:0xf bank_mask:0xf
  v_add_f32_dpp v45, v45, v45 quad_perm:[2,3,0,1] row_mask:0xf bank_mask:0xf
  v_add_f32_dpp v46, v46, v46 quad_perm:[2,3,0,1] row_mask:0xf bank_mask:0xf
  v_add_f32_dpp v47, v47, v47 quad_perm:[2,3,0,1] row_mask:0xf bank_mask:0xf
  v_add_f32_dpp v48, v48, v48 quad_perm:[2,3,0,1] row_mask:0xf bank_mask:0xf
  v_add_f32_dpp v49, v49, v49 quad_perm:[2,3,0,1] row_mask:0xf bank_mask:0xf
  v_add_f32_dpp v50, v50, v50 quad_perm:[2,3,0,1] row_mask:0xf bank_mask:0xf
  v_add_f32_dpp v51, v51, v51 quad_perm:[2,3,0,1] row_mask:0xf bank_mask:0xf
  v_add_f32_dpp v52, v52, v52 quad_perm:[2,3,0,1] row_mask:0xf bank_mask:0xf
  v_add_f32_dpp v53, v53, v53 quad_perm:[2,3,0,1] row_mask:0xf bank_mask:0xf
  v_add_f32_dpp v54, v54, v54 quad_perm:[2,3,0,1] row_mask:0xf bank_mask:0xf
  v_add_f32_dpp v55, v55, v55 quad_perm:[2,3,0,1] row_mask:0xf bank_mask:0xf
  v_add_f32_dpp v56, v56, v56 quad_perm:[2,3,0,1] row_mask:0xf bank_mask:0xf
  v_add_f32_dpp v57, v57, v57 quad_perm:[2,3,0,1] row_mask:0xf bank_mask:0xf
  v_add_f32_dpp v58, v58, v58 quad_perm:[2,3,0,1] row_mask:0xf bank_mask:0xf
  v_add_f32_dpp v59, v59, v59 quad_perm:[2,3,0,1] row_mask:0xf bank_mask:0xf
  v_cvt_pk_bf16_f32 v28, v44, v45
  v_cvt_pk_bf16_f32 v29, v46, v47
  v_cvt_pk_bf16_f32 v30, v48, v49
  v_cvt_pk_bf16_f32 v31, v50, v51
  v_cvt_pk_bf16_f32 v32, v52, v53
  v_cvt_pk_bf16_f32 v33, v54, v55
  v_cvt_pk_bf16_f32 v34, v56, v57
  v_cvt_pk_bf16_f32 v35, v58, v59
  s_waitcnt lgkmcnt(0)
  v_mfma_f32_16x16x32_bf16 v[44:47], v[28:31], v[64:67], 0
  v_mfma_f32_16x16x32_bf16 v[48:51], v[28:31], v[68:71], 0
  v_mfma_f32_16x16x32_bf16 v[52:55], v[28:31], v[72:75], 0
  v_mfma_f32_16x16x32_bf16 v[56:59], v[28:31], v[76:79], 0
  v_mfma_f32_16x16x32_bf16 v[12:15], v[28:31], v[80:83], 0
  v_mfma_f32_16x16x32_bf16 v[16:19], v[28:31], v[84:87], 0
  v_mfma_f32_16x16x32_bf16 v[20:23], v[28:31], v[88:91], 0
  v_mfma_f32_16x16x32_bf16 v[24:27], v[28:31], v[92:95], 0
  v_mfma_f32_16x16x32_bf16 v[44:47], v[32:35], v[96:99], v[44:47]
  v_mfma_f32_16x16x32_bf16 v[48:51], v[32:35], v[100:103], v[48:51]
  v_mfma_f32_16x16x32_bf16 v[52:55], v[32:35], v[104:107], v[52:55]
  v_mfma_f32_16x16x32_bf16 v[56:59], v[32:35], v[108:111], v[56:59]
  v_mfma_f32_16x16x32_bf16 v[12:15], v[32:35], v[112:115], v[12:15]
  v_mfma_f32_16x16x32_bf16 v[16:19], v[32:35], v[116:119], v[16:19]
  v_mfma_f32_16x16x32_bf16 v[20:23], v[32:35], v[120:123], v[20:23]
  v_mfma_f32_16x16x32_bf16 v[24:27], v[32:35], v[124:127], v[24:27]
  s_nop 1
  v_cndmask_b32 v36, v44, v48, s[96:97]
  s_nop 0
  v_cndmask_b32 v37, v52, v56, s[96:97]
  s_nop 0
  v_cndmask_b32 v38, v12, v16, s[96:97]
  s_nop 0
  v_cndmask_b32 v39, v20, v24, s[96:97]
  v_and_or_b32 v36, v36, s76, v4
  v_and_or_b32 v37, v37, s76, v4
  v_and_or_b32 v38, v38, s76, v4
  v_and_or_b32 v39, v39, s76, v4
  buffer_store_dword v36, v43, s[48:51], s100 offen sc1
  s_add_u32 s100, s100, 8192
  buffer_store_dword v37, v43, s[48:51], s100 offen sc1
  s_add_u32 s100, s100, 8192
  buffer_store_dword v38, v43, s[48:51], s100 offen sc1
  s_add_u32 s100, s100, 8192
  buffer_store_dword v39, v43, s[48:51], s100 offen sc1
  s_branch L_FIN
FFN_30:
  s_waitcnt vmcnt(0)
  s_barrier
  v_lshrrev_b32 v8, 2, v2
  v_and_b32 v9, 3, v2
  v_lshl_add_u32 v5, v3, 3, v8
  v_lshlrev_b32 v5, 6, v5
  v_lshl_add_u32 v5, v9, 3, v5
  s_lshl_b32 s11, s3, 13
  v_add_u32 v5, s11, v5
  ds_read_b64_tr_b16 v[64:65], v5 offset:20480
  ds_read_b64_tr_b16 v[66:67], v5 offset:20736
  ds_read_b64_tr_b16 v[68:69], v5 offset:20512
  ds_read_b64_tr_b16 v[70:71], v5 offset:20768
  ds_read_b64_tr_b16 v[72:73], v5 offset:22528
  ds_read_b64_tr_b16 v[74:75], v5 offset:22784
  ds_read_b64_tr_b16 v[76:77], v5 offset:22560
  ds_read_b64_tr_b16 v[78:79], v5 offset:22816
  ds_read_b64_tr_b16 v[80:81], v5 offset:24576
  ds_read_b64_tr_b16 v[82:83], v5 offset:24832
  ds_read_b64_tr_b16 v[84:85], v5 offset:24608
  ds_read_b64_tr_b16 v[86:87], v5 offset:24864
  ds_read_b64_tr_b16 v[88:89], v5 offset:26624
  ds_read_b64_tr_b16 v[90:91], v5 offset:26880
  ds_read_b64_tr_b16 v[92:93], v5 offset:26656
  ds_read_b64_tr_b16 v[94:95], v5 offset:26912
  v_lshl_add_u32 v6, v3, 3, v8
  s_movk_i32 s11, 1056
  v_mul_lo_u32 v6, v6, s11
  v_lshl_add_u32 v6, v9, 3, v6
  s_lshl_b32 s11, s3, 8
  v_add_u32 v6, s11, v6
  v_add_u32 v59, 53248, v6
  v_lshlrev_b32 v10, 5, v1
  s_mov_b32 s98, 0x100000
  v_lshlrev_b32 v11, 4, v1
  s_lshl_b32 s11, s3, 11
  v_add_u32 v11, s11, v11
  v_bfe_u32 v7, v2, 2, 1
  v_lshlrev_b32 v52, 10, v7
  v_lshl_add_u32 v52, v3, 4, v52
  s_mul_i32 s11, s3, 2304
  v_add_u32 v52, s11, v52
  v_and_b32 v53, 1, v3
  v_lshlrev_b32 v53, 7, v53
  v_lshrrev_b32 v5, 1, v3
  v_lshl_add_u32 v53, v5, 6, v53
  v_lshl_add_u32 v53, v2, 2, v53
  s_lshl_b32 s11, s3, 8
  v_add_u32 v53, s11, v53
  v_lshlrev_b32 v54, 2, v1
  s_lshl_b32 s11, s3, 7
  v_lshlrev_b32 v55, 1, v1
  v_add_u32 v55, s11, v55
  v_lshlrev_b32 v56, 6, v7
  v_lshl_add_u32 v56, v3, 4, v56
  v_add_u32 v56, s11, v56
  v_and_b32 v57, 1, v3
  s_mov_b32 s11, 98304
  v_mul_lo_u32 v57, v57, s11
  v_lshrrev_b32 v6, 1, v3
  s_movk_i32 s11, 3072
  v_mul_lo_u32 v6, v6, s11
  v_add_u32 v57, v57, v6
  v_lshl_add_u32 v57, v2, 2, v57
  s_mul_i32 s99, s3, 24576
  s_lshl_b32 s12, s95, 6
  s_add_u32 s99, s99, s12
  s_add_u32 s99, s99, 0x110000
  s_mov_b32 s96, 0
  s_mov_b32 s97, -1
  s_waitcnt lgkmcnt(0)
  v_mov_b32 v36, 0x3f803f80
  v_mov_b32 v37, 0x3f803f80
  v_mov_b32 v38, 0x3f803f80
  v_mov_b32 v39, 0x3f803f80
  s_nop 1
  v_mfma_f32_16x16x32_bf16 v[28:31], v[36:39], v[64:67], 0
  v_mfma_f32_16x16x32_bf16 v[32:35], v[36:39], v[68:71], 0
  v_mfma_f32_16x16x32_bf16 v[28:31], v[36:39], v[72:75], v[28:31]
  v_mfma_f32_16x16x32_bf16 v[32:35], v[36:39], v[76:79], v[32:35]
  v_mfma_f32_16x16x32_bf16 v[28:31], v[36:39], v[80:83], v[28:31]
  v_mfma_f32_16x16x32_bf16 v[32:35], v[36:39], v[84:87], v[32:35]
  v_mfma_f32_16x16x32_bf16 v[28:31], v[36:39], v[88:91], v[28:31]
  v_mfma_f32_16x16x32_bf16 v[32:35], v[36:39], v[92:95], v[32:35]
  s_nop 7
  v_cndmask_b32 v58, v28, v32, s[96:97]
  s_mov_b32 s100, 0xffff0000
  s_mov_b32 s101, 0xffff0000
  s_mov_b32 s94, 400000
  buffer_load_dwordx4 v[96:99], v10, s[48:51], s98 offen sc1
  buffer_load_dwordx4 v[100:103], v10, s[48:51], s98 offen offset:16 sc1
  buffer_load_dwordx4 v[104:107], v10, s[48:51], s98 offen offset:2048 sc1
  buffer_load_dwordx4 v[108:111], v10, s[48:51], s98 offen offset:2064 sc1
  s_sleep 3
P2_38:
  buffer_load_dwordx4 v[112:115], v10, s[48:51], s98 offen sc1
  buffer_load_dwordx4 v[116:119], v10, s[48:51], s98 offen offset:16 sc1
  buffer_load_dwordx4 v[120:123], v10, s[48:51], s98 offen offset:2048 sc1
  buffer_load_dwordx4 v[124:127], v10, s[48:51], s98 offen offset:2064 sc1
  s_waitcnt vmcnt(4)
  v_xor_b32 v12, v4, v96
  v_xor_b32 v13, v4, v97
  v_xor_b32 v14, v4, v98
  v_xor_b32 v15, v4, v99
  v_xor_b32 v16, v4, v100
  v_xor_b32 v17, v4, v101
  v_xor_b32 v18, v4, v102
  v_xor_b32 v19, v4, v103
  v_xor_b32 v20, v4, v104
  v_xor_b32 v21, v4, v105
  v_xor_b32 v22, v4, v106
  v_xor_b32 v23, v4, v107
  v_xor_b32 v24, v4, v108
  v_xor_b32 v25, v4, v109
  v_xor_b32 v26, v4, v110
  v_xor_b32 v27, v4, v111
  v_or3_b32 v7, v12, v13, v14
  v_or3_b32 v7, v7, v15, v16
  v_or3_b32 v7, v7, v17, v18
  v_or3_b32 v7, v7, v19, v20
  v_or3_b32 v7, v7, v21, v22
  v_or3_b32 v7, v7, v23, v24
  v_or3_b32 v7, v7, v25, v26
  v_or_b32 v7, v7, v27
  v_and_b32 v7, 0x3ff, v7
  v_cmp_ne_u32 vcc, 0, v7
  s_cbranch_vccz P2OK_39
  buffer_load_dwordx4 v[96:99], v10, s[48:51], s98 offen sc1
  buffer_load_dwordx4 v[100:103], v10, s[48:51], s98 offen offset:16 sc1
  buffer_load_dwordx4 v[104:107], v10, s[48:51], s98 offen offset:2048 sc1
  buffer_load_dwordx4 v[108:111], v10, s[48:51], s98 offen offset:2064 sc1
  s_waitcnt vmcnt(4)
  v_xor_b32 v12, v4, v112
  v_xor_b32 v13, v4, v113
  v_xor_b32 v14, v4, v114
  v_xor_b32 v15, v4, v115
  v_xor_b32 v16, v4, v116
  v_xor_b32 v17, v4, v117
  v_xor_b32 v18, v4, v118
  v_xor_b32 v19, v4, v119
  v_xor_b32 v20, v4, v120
  v_xor_b32 v21, v4, v121
  v_xor_b32 v22, v4, v122
  v_xor_b32 v23, v4, v123
  v_xor_b32 v24, v4, v124
  v_xor_b32 v25, v4, v125
  v_xor_b32 v26, v4, v126
  v_xor_b32 v27, v4, v127
  v_or3_b32 v7, v12, v13, v14
  v_or3_b32 v7, v7, v15, v16
  v_or3_b32 v7, v7, v17, v18
  v_or3_b32 v7, v7, v19, v20
  v_or3_b32 v7, v7, v21, v22
  v_or3_b32 v7, v7, v23, v24
  v_or3_b32 v7, v7, v25, v26
  v_or_b32 v7, v7, v27
  v_and_b32 v7, 0x3ff, v7
  v_cmp_ne_u32 vcc, 0, v7
  s_cbranch_vccz P2OK_39
  s_sub_u32 s94, s94, 1
  s_cbranch_scc1 P2OK_39
  s_branch P2_38
P2OK_39:
  v_cvt_pk_bf16_f32 v36, v12, v13
  v_cvt_pk_bf16_f32 v40, v20, v21
  v_cvt_pk_bf16_f32 v37, v14, v15
  v_cvt_pk_bf16_f32 v41, v22, v23
  v_cvt_pk_bf16_f32 v38, v16, v17
  v_cvt_pk_bf16_f32 v42, v24, v25
  v_cvt_pk_bf16_f32 v39, v18, v19
  v_cvt_pk_bf16_f32 v43, v26, v27
  ds_write_b128 v11, v[36:39] offset:11264
  ds_write_b128 v11, v[40:43] offset:12288
  v_pk_add_f32 v[60:61], v[12:13], v[14:15]
  v_pk_mul_f32 v[32:33], v[12:13], v[12:13]
  v_pk_add_f32 v[62:63], v[20:21], v[22:23]
  v_pk_mul_f32 v[34:35], v[20:21], v[20:21]
  v_pk_add_f32 v[60:61], v[60:61], v[16:17]
  v_pk_add_f32 v[62:63], v[62:63], v[24:25]
  v_pk_add_f32 v[60:61], v[60:61], v[18:19]
  v_pk_add_f32 v[62:63], v[62:63], v[26:27]
  v_pk_fma_f32 v[32:33], v[14:15], v[14:15], v[32:33]
  v_pk_fma_f32 v[34:35], v[22:23], v[22:23], v[34:35]
  v_pk_fma_f32 v[32:33], v[16:17], v[16:17], v[32:33]
  v_pk_fma_f32 v[34:35], v[24:25], v[24:25], v[34:35]
  v_pk_fma_f32 v[32:33], v[18:19], v[18:19], v[32:33]
  v_pk_fma_f32 v[34:35], v[26:27], v[26:27], v[34:35]
  v_add_f32 v28, v60, v61
  v_add_f32 v29, v32, v33
  v_add_f32 v30, v62, v63
  v_add_f32 v31, v34, v35
  s_waitcnt lgkmcnt(0)
  ds_read_b128 v[36:39], v52 offset:11264
  ds_read_b128 v[40:43], v52 offset:11328
  ds_read_b128 v[44:47], v52 offset:11392
  ds_read_b128 v[48:51], v52 offset:11456
  v_add_f32_dpp v28, v28, v28 row_ror:8 row_mask:0xf bank_mask:0xf
  v_add_f32_dpp v29, v29, v29 row_ror:8 row_mask:0xf bank_mask:0xf
  v_add_f32_dpp v30, v30, v30 row_ror:8 row_mask:0xf bank_mask:0xf
  v_add_f32_dpp v31, v31, v31 row_ror:8 row_mask:0xf bank_mask:0xf
  v_add_f32_dpp v28, v28, v28 row_ror:4 row_mask:0xf bank_mask:0xf
  v_add_f32_dpp v29, v29, v29 row_ror:4 row_mask:0xf bank_mask:0xf
  v_add_f32_dpp v30, v30, v30 row_ror:4 row_mask:0xf bank_mask:0xf
  v_add_f32_dpp v31, v31, v31 row_ror:4 row_mask:0xf bank_mask:0xf
  v_add_f32_dpp v28, v28, v28 row_ror:2 row_mask:0xf bank_mask:0xf
  v_add_f32_dpp v29, v29, v29 row_ror:2 row_mask:0xf bank_mask:0xf
  v_add_f32_dpp v30, v30, v30 row_ror:2 row_mask:0xf bank_mask:0xf
  v_add_f32_dpp v31, v31, v31 row_ror:2 row_mask:0xf bank_mask:0xf
  v_add_f32_dpp v28, v28, v28 row_ror:1 row_mask:0xf bank_mask:0xf
  v_add_f32_dpp v29, v29, v29 row_ror:1 row_mask:0xf bank_mask:0xf
  v_add_f32_dpp v30, v30, v30 row_ror:1 row_mask:0xf bank_mask:0xf
  v_add_f32_dpp v31, v31, v31 row_ror:1 row_mask:0xf bank_mask:0xf
  v_add_f32_dpp v28, v28, v28 row_bcast:15 row_mask:0xa bank_mask:0xf
  v_add_f32_dpp v29, v29, v29 row_bcast:15 row_mask:0xa bank_mask:0xf
  v_add_f32_dpp v30, v30, v30 row_bcast:15 row_mask:0xa bank_mask:0xf
  v_add_f32_dpp v31, v31, v31 row_bcast:15 row_mask:0xa bank_mask:0xf
  v_add_f32_dpp v28, v28, v28 row_bcast:31 row_mask:0xc bank_mask:0xf
  v_add_f32_dpp v29, v29, v29 row_bcast:31 row_mask:0xc bank_mask:0xf
  v_add_f32_dpp v30, v30, v30 row_bcast:31 row_mask:0xc bank_mask:0xf
  v_add_f32_dpp v31, v31, v31 row_bcast:31 row_mask:0xc bank_mask:0xf
  v_readlane_b32 s11, v28, 63
  v_readlane_b32 s12, v29, 63
  v_readlane_b32 s13, v30, 63
  v_readlane_b32 s14, v31, 63
  s_waitcnt lgkmcnt(0)
  v_mfma_f32_16x16x32_bf16 v[12:15], v[36:39], v[64:67], 0
  v_mfma_f32_16x16x32_bf16 v[16:19], v[36:39], v[68:71], 0
  v_mfma_f32_16x16x32_bf16 v[12:15], v[40:43], v[72:75], v[12:15]
  v_mfma_f32_16x16x32_bf16 v[16:19], v[40:43], v[76:79], v[16:19]
  v_mfma_f32_16x16x32_bf16 v[12:15], v[44:47], v[80:83], v[12:15]
  v_mfma_f32_16x16x32_bf16 v[16:19], v[44:47], v[84:87], v[16:19]
  v_mfma_f32_16x16x32_bf16 v[12:15], v[48:51], v[88:91], v[12:15]
  v_mfma_f32_16x16x32_bf16 v[16:19], v[48:51], v[92:95], v[16:19]
  v_mov_b32 v28, s11
  v_mov_b32 v29, s13
  v_mov_b32 v30, s12
  v_mov_b32 v31, s14
  v_mul_f32 v28, 0x3b000000, v28
  v_mul_f32 v29, 0x3b000000, v29
  v_mul_f32 v30, 0x3b000000, v30
  v_mul_f32 v31, 0x3b000000, v31
  v_fma_f32 v30, -v28, v28, v30
  v_fma_f32 v31, -v29, v29, v31
  v_max_f32 v30, 0, v30
  v_max_f32 v31, 0, v31
  v_cvt_pk_bf16_f32 v32, v28, v29
  v_cvt_pk_bf16_f32 v33, v30, v31
  v_lshlrev_b32 v28, 16, v32
  v_and_b32 v29, 0xffff0000, v32
  v_lshlrev_b32 v30, 16, v33
  v_and_b32 v31, 0xffff0000, v33
  v_add_f32 v30, 0x3727c5ac, v30
  v_add_f32 v31, 0x3727c5ac, v31
  v_cvt_pk_bf16_f32 v33, v30, v31
  v_lshlrev_b32 v30, 16, v33
  v_and_b32 v31, 0xffff0000, v33
  v_sqrt_f32 v30, v30
  v_sqrt_f32 v31, v31
  s_nop 0
  v_cvt_pk_bf16_f32 v33, v30, v31
  v_lshlrev_b32 v30, 16, v33
  v_and_b32 v31, 0xffff0000, v33
  v_rcp_f32 v30, v30
  v_rcp_f32 v31, v31
  v_cndmask_b32 v28, v28, v29, s[100:101]
  v_cndmask_b32 v30, v30, v31, s[100:101]
  v_cndmask_b32 v12, v12, v16, s[96:97]
  v_fma_f32 v12, -v28, v58, v12
  v_mul_f32 v12, v12, v30
  ds_write_b32 v53, v12 offset:8704
  s_waitcnt vmcnt(0) lgkmcnt(0)
  s_barrier
  ds_read_b32 v28, v54 offset:8704
  ds_read_b32 v29, v54 offset:8960
  ds_read_b32 v30, v54 offset:9216
  ds_read_b32 v31, v54 offset:9472
  ds_read_b64_tr_b16 v[96:97], v59 offset:0
  ds_read_b64_tr_b16 v[98:99], v59 offset:4224
  ds_read_b64_tr_b16 v[100:101], v59 offset:32
  ds_read_b64_tr_b16 v[102:103], v59 offset:4256
  ds_read_b64_tr_b16 v[104:105], v59 offset:64
  ds_read_b64_tr_b16 v[106:107], v59 offset:4288
  ds_read_b64_tr_b16 v[108:109], v59 offset:96
  ds_read_b64_tr_b16 v[110:111], v59 offset:4320
  ds_read_b64_tr_b16 v[112:113], v59 offset:128
  ds_read_b64_tr_b16 v[114:115], v59 offset:4352
  ds_read_b64_tr_b16 v[116:117], v59 offset:160
  ds_read_b64_tr_b16 v[118:119], v59 offset:4384
  ds_read_b64_tr_b16 v[120:121], v59 offset:192
  ds_read_b64_tr_b16 v[122:123], v59 offset:4416
  ds_read_b64_tr_b16 v[124:125], v59 offset:224
  ds_read_b64_tr_b16 v[126:127], v59 offset:4448
  s_waitcnt lgkmcnt(15)
  v_add_f32 v28, v28, v29
  v_add_f32 v30, v30, v31
  v_add_f32 v28, v28, v30
  v_cvt_pk_bf16_f32 v29, v28, v28
  v_lshlrev_b32 v28, 16, v29
  v_mul_f32 v29, 0xbfb8aa3b, v28
  v_exp_f32 v29, v29
  s_nop 0
  v_add_f32 v29, 1.0, v29
  v_rcp_f32 v29, v29
  s_nop 0
  v_mul_f32 v28, v28, v29
  v_cvt_pk_bf16_f32 v28, v28, v28
  ds_write_b16 v55, v28 offset:9728
  s_waitcnt lgkmcnt(0)
  ds_read_b128 v[28:31], v56 offset:9728
  s_waitcnt lgkmcnt(0)
  s_waitcnt vmcnt(0)
  v_mfma_f32_16x16x32_bf16 v[12:15], v[28:31], v[96:99], 0
  v_mfma_f32_16x16x32_bf16 v[16:19], v[28:31], v[100:103], 0
  v_mfma_f32_16x16x32_bf16 v[20:23], v[28:31], v[104:107], 0
  v_mfma_f32_16x16x32_bf16 v[24:27], v[28:31], v[108:111], 0
  v_mfma_f32_16x16x32_bf16 v[36:39], v[28:31], v[112:115], 0
  v_mfma_f32_16x16x32_bf16 v[40:43], v[28:31], v[116:119], 0
  v_mfma_f32_16x16x32_bf16 v[44:47], v[28:31], v[120:123], 0
  v_mfma_f32_16x16x32_bf16 v[48:51], v[28:31], v[124:127], 0
  s_nop 1
  v_cndmask_b32 v32, v12, v16, s[96:97]
  s_nop 0
  v_cndmask_b32 v33, v20, v24, s[96:97]
  s_nop 0
  v_cndmask_b32 v34, v36, v40, s[96:97]
  s_nop 0
  v_cndmask_b32 v35, v44, v48, s[96:97]
  v_and_or_b32 v32, v32, s76, v4
  v_and_or_b32 v33, v33, s76, v4
  v_and_or_b32 v34, v34, s76, v4
  v_and_or_b32 v35, v35, s76, v4
  buffer_store_dword v32, v57, s[48:51], s99 offen sc1
  s_add_u32 s99, s99, 6144
  buffer_store_dword v33, v57, s[48:51], s99 offen sc1
  s_add_u32 s99, s99, 6144
  buffer_store_dword v34, v57, s[48:51], s99 offen sc1
  s_add_u32 s99, s99, 6144
  buffer_store_dword v35, v57, s[48:51], s99 offen sc1
  s_branch L_FIN
RED_31:
  s_cmp_eq_u32 s3, 0
  s_cbranch_scc0 L_FIN
  v_and_b32 v6, 1, v3
  v_lshlrev_b32 v6, 1, v6
  v_lshrrev_b32 v7, 1, v3
  v_or_b32 v6, v6, v7
  v_and_b32 v60, 3, v1
  v_lshl_add_u32 v60, v60, 2, v6
  v_lshlrev_b32 v62, 1, v60
  s_lshl_b32 s11, s95, 5
  buffer_load_ushort v61, v62, s[52:55], s11 offen
  v_lshlrev_b32 v8, 4, v1
  v_lshlrev_b32 v9, 2, v60
  s_lshl_b32 s98, s95, 12
  s_add_u32 s98, s98, 0x80000
  s_lshl_b32 s100, s95, 6
  s_add_u32 s100, s100, 0x100000
  s_lshl_b32 s101, s95, 5
  s_mul_i32 s11, s95, 3072
  s_add_u32 s11, s11, 0x110000
  s_add_u32 s60, s36, s11
  s_addc_u32 s61, s37, 0
  s_mov_b32 s62, 2752
  s_mov_b32 s63, 0x20000
  s_mov_b32 s94, 400000
  buffer_load_dwordx4 v[64:67], v8, s[48:51], s98 offen offset:0 sc1
  buffer_load_dwordx4 v[68:71], v8, s[48:51], s98 offen offset:1024 sc1
  buffer_load_dwordx4 v[72:75], v8, s[48:51], s98 offen offset:2048 sc1
  buffer_load_dwordx4 v[76:79], v8, s[48:51], s98 offen offset:3072 sc1
  s_sleep 3
P2_40:
  buffer_load_dwordx4 v[80:83], v8, s[48:51], s98 offen offset:0 sc1
  buffer_load_dwordx4 v[84:87], v8, s[48:51], s98 offen offset:1024 sc1
  buffer_load_dwordx4 v[88:91], v8, s[48:51], s98 offen offset:2048 sc1
  buffer_load_dwordx4 v[92:95], v8, s[48:51], s98 offen offset:3072 sc1
  s_waitcnt vmcnt(4)
  v_xor_b32 v32, v4, v64
  v_xor_b32 v33, v4, v65
  v_xor_b32 v34, v4, v66
  v_xor_b32 v35, v4, v67
  v_xor_b32 v36, v4, v68
  v_xor_b32 v37, v4, v69
  v_xor_b32 v38, v4, v70
  v_xor_b32 v39, v4, v71
  v_xor_b32 v40, v4, v72
  v_xor_b32 v41, v4, v73
  v_xor_b32 v42, v4, v74
  v_xor_b32 v43, v4, v75
  v_xor_b32 v44, v4, v76
  v_xor_b32 v45, v4, v77
  v_xor_b32 v46, v4, v78
  v_xor_b32 v47, v4, v79
  v_or3_b32 v7, v32, v33, v34
  v_or3_b32 v7, v7, v35, v36
  v_or3_b32 v7, v7, v37, v38
  v_or3_b32 v7, v7, v39, v40
  v_or3_b32 v7, v7, v41, v42
  v_or3_b32 v7, v7, v43, v44
  v_or3_b32 v7, v7, v45, v46
  v_or_b32 v7, v7, v47
  v_and_b32 v7, 0x3ff, v7
  v_cmp_ne_u32 vcc, 0, v7
  s_cbranch_vccz P2OK_41
  buffer_load_dwordx4 v[64:67], v8, s[48:51], s98 offen offset:0 sc1
  buffer_load_dwordx4 v[68:71], v8, s[48:51], s98 offen offset:1024 sc1
  buffer_load_dwordx4 v[72:75], v8, s[48:51], s98 offen offset:2048 sc1
  buffer_load_dwordx4 v[76:79], v8, s[48:51], s98 offen offset:3072 sc1
  s_waitcnt vmcnt(4)
  v_xor_b32 v32, v4, v80
  v_xor_b32 v33, v4, v81
  v_xor_b32 v34, v4, v82
  v_xor_b32 v35, v4, v83
  v_xor_b32 v36, v4, v84
  v_xor_b32 v37, v4, v85
  v_xor_b32 v38, v4, v86
  v_xor_b32 v39, v4, v87
  v_xor_b32 v40, v4, v88
  v_xor_b32 v41, v4, v89
  v_xor_b32 v42, v4, v90
  v_xor_b32 v43, v4, v91
  v_xor_b32 v44, v4, v92
  v_xor_b32 v45, v4, v93
  v_xor_b32 v46, v4, v94
  v_xor_b32 v47, v4, v95
  v_or3_b32 v7, v32, v33, v34
  v_or3_b32 v7, v7, v35, v36
  v_or3_b32 v7, v7, v37, v38
  v_or3_b32 v7, v7, v39, v40
  v_or3_b32 v7, v7, v41, v42
  v_or3_b32 v7, v7, v43, v44
  v_or3_b32 v7, v7, v45, v46
  v_or_b32 v7, v7, v47
  v_and_b32 v7, 0x3ff, v7
  v_cmp_ne_u32 vcc, 0, v7
  s_cbranch_vccz P2OK_41
  s_sub_u32 s94, s94, 1
  s_cbranch_scc1 P2OK_41
  s_branch P2_40
P2OK_41:
  v_lshlrev_b32 v61, 16, v61
  v_add_f32 v96, v32, v36
  v_add_f32 v100, v40, v44
  v_add_f32 v97, v33, v37
  v_add_f32 v101, v41, v45
  v_add_f32 v98, v34, v38
  v_add_f32 v102, v42, v46
  v_add_f32 v99, v35, v39
  v_add_f32 v103, v43, v47
  v_add_f32 v96, v96, v100
  v_add_f32 v97, v97, v101
  v_add_f32 v98, v98, v102
  v_add_f32 v99, v99, v103
  v_permlane32_swap_b32 v96, v97
  s_nop 0
  v_permlane32_swap_b32 v98, v99
  v_add_f32 v96, v96, v97
  v_add_f32 v98, v98, v99
  s_nop 1
  v_permlane16_swap_b32 v96, v98
  v_add_f32 v63, v96, v98
  s_nop 1
  v_add_f32_dpp v63, v63, v63 row_ror:8 row_mask:0xf bank_mask:0xf
  s_nop 1
  v_add_f32_dpp v63, v63, v63 row_ror:4 row_mask:0xf bank_mask:0xf
  v_cvt_pk_bf16_f32 v63, v63, v63
  v_lshlrev_b32 v63, 16, v63
  v_add_f32 v63, v63, v61
  v_cvt_pk_bf16_f32 v63, v63, v63
  v_lshlrev_b32 v63, 16, v63
  v_and_or_b32 v12, v63, s76, v4
  s_mov_b32 exec_lo, 0x000f000f
  s_mov_b32 exec_hi, 0x000f000f
  buffer_store_dword v12, v9, s[48:51], s100 offen sc1
  s_mov_b64 exec, -1
  s_mov_b32 s96, 0
  s_mov_b32 s97, 0xfffff000
  s_mov_b32 s94, 400000
  buffer_load_dwordx4 v[104:107], v8, s[60:63], 0 offen offset:0 sc1
  buffer_load_dwordx4 v[108:111], v8, s[60:63], 0 offen offset:1024 sc1
  buffer_load_dwordx4 v[112:115], v8, s[60:63], 0 offen offset:2048 sc1
  s_sleep 3
P2_42:
  buffer_load_dwordx4 v[116:119], v8, s[60:63], 0 offen offset:0 sc1
  buffer_load_dwordx4 v[120:123], v8, s[60:63], 0 offen offset:1024 sc1
  buffer_load_dwordx4 v[124:127], v8, s[60:63], 0 offen offset:2048 sc1
  s_waitcnt vmcnt(3)
  v_xor_b32 v16, v4, v104
  v_xor_b32 v17, v4, v105
  v_xor_b32 v18, v4, v106
  v_xor_b32 v19, v4, v107
  v_xor_b32 v20, v4, v108
  v_xor_b32 v21, v4, v109
  v_xor_b32 v22, v4, v110
  v_xor_b32 v23, v4, v111
  v_xor_b32 v24, v4, v112
  v_xor_b32 v25, v4, v113
  v_xor_b32 v26, v4, v114
  v_xor_b32 v27, v4, v115
  v_cndmask_b32 v24, v24, 0, s[96:97]
  v_cndmask_b32 v25, v25, 0, s[96:97]
  v_cndmask_b32 v26, v26, 0, s[96:97]
  v_cndmask_b32 v27, v27, 0, s[96:97]
  v_or3_b32 v7, v16, v17, v18
  v_or3_b32 v7, v7, v19, v20
  v_or3_b32 v7, v7, v21, v22
  v_or3_b32 v7, v7, v23, v24
  v_or3_b32 v7, v7, v25, v26
  v_or_b32 v7, v7, v27
  v_and_b32 v7, 0x3ff, v7
  v_cmp_ne_u32 vcc, 0, v7
  s_cbranch_vccz P2OK_43
  buffer_load_dwordx4 v[104:107], v8, s[60:63], 0 offen offset:0 sc1
  buffer_load_dwordx4 v[108:111], v8, s[60:63], 0 offen offset:1024 sc1
  buffer_load_dwordx4 v[112:115], v8, s[60:63], 0 offen offset:2048 sc1
  s_waitcnt vmcnt(3)
  v_xor_b32 v16, v4, v116
  v_xor_b32 v17, v4, v117
  v_xor_b32 v18, v4, v118
  v_xor_b32 v19, v4, v119
  v_xor_b32 v20, v4, v120
  v_xor_b32 v21, v4, v121
  v_xor_b32 v22, v4, v122
  v_xor_b32 v23, v4, v123
  v_xor_b32 v24, v4, v124
  v_xor_b32 v25, v4, v125
  v_xor_b32 v26, v4, v126
  v_xor_b32 v27, v4, v127
  v_cndmask_b32 v24, v24, 0, s[96:97]
  v_cndmask_b32 v25, v25, 0, s[96:97]
  v_cndmask_b32 v26, v26, 0, s[96:97]
  v_cndmask_b32 v27, v27, 0, s[96:97]
  v_or3_b32 v7, v16, v17, v18
  v_or3_b32 v7, v7, v19, v20
  v_or3_b32 v7, v7, v21, v22
  v_or3_b32 v7, v7, v23, v24
  v_or3_b32 v7, v7, v25, v26
  v_or_b32 v7, v7, v27
  v_and_b32 v7, 0x3ff, v7
  v_cmp_ne_u32 vcc, 0, v7
  s_cbranch_vccz P2OK_43
  s_sub_u32 s94, s94, 1
  s_cbranch_scc1 P2OK_43
  s_branch P2_42
P2OK_43:
  v_add_f32 v96, v16, v20
  v_add_f32 v97, v17, v21
  v_add_f32 v98, v18, v22
  v_add_f32 v99, v19, v23
  v_add_f32 v96, v96, v24
  v_add_f32 v97, v97, v25
  v_add_f32 v98, v98, v26
  v_add_f32 v99, v99, v27
  v_permlane32_swap_b32 v96, v97
  s_nop 0
  v_permlane32_swap_b32 v98, v99
  v_add_f32 v96, v96, v97
  v_add_f32 v98, v98, v99
  s_nop 1
  v_permlane16_swap_b32 v96, v98
  v_add_f32 v12, v96, v98
  s_nop 1
  v_add_f32_dpp v12, v12, v12 row_ror:8 row_mask:0xf bank_mask:0xf
  s_nop 1
  v_add_f32_dpp v12, v12, v12 row_ror:4 row_mask:0xf bank_mask:0xf
  v_cvt_pk_bf16_f32 v12, v12, v12
  v_lshlrev_b32 v12, 16, v12
  v_add_f32 v12, v12, v63
  v_cvt_pk_bf16_f32 v12, v12, v12
  s_mov_b32 exec_lo, 0x000f000f
  s_mov_b32 exec_hi, 0x000f000f
  buffer_store_short v12, v62, s[68:71], s101 offen
  s_mov_b64 exec, -1
  s_cmp_eq_u32 s95, 0
  s_cbranch_scc0 NEP_44
  v_mov_b32 v13, s10
  v_mov_b32 v14, 0
  s_mov_b32 s11, 0x30000
  s_mov_b64 exec, 1
  buffer_store_dword v13, v14, s[48:51], s11 offen sc1
  s_mov_b64 exec, -1
NEP_44:
  s_branch L_FIN
XW_28:
  s_cmp_ge_u32 s3, 16
  s_cbranch_scc0 WSP2_45
  s_cmp_eq_u32 s27, 1
  s_cbranch_scc0 NWD_46
  s_lshl_b32 s13, s3, 12
  v_lshlrev_b32 v5, 4, v1
  s_mul_i32 s12, s3, 4224
  s_add_u32 s12, s12, 20480
  s_mov_b32 m0, s12
  s_nop 0
  buffer_load_dwordx4 v5, s[60:63], s13 offen nt lds
  s_add_u32 s12, s12, 1056
  s_add_u32 s13, s13, 1024
  s_mov_b32 m0, s12
  s_nop 0
  buffer_load_dwordx4 v5, s[60:63], s13 offen nt lds
  s_add_u32 s12, s12, 1056
  s_add_u32 s13, s13, 1024
  s_mov_b32 m0, s12
  s_nop 0
  buffer_load_dwordx4 v5, s[60:63], s13 offen nt lds
  s_add_u32 s12, s12, 1056
  s_add_u32 s13, s13, 1024
  s_mov_b32 m0, s12
  s_nop 0
  buffer_load_dwordx4 v5, s[60:63], s13 offen nt lds
NWD_46:
WSP2_45:
  s_cmp_eq_u32 s27, 2
  s_cbranch_scc0 NFD_47
  s_lshl_b32 s11, s3, 5
  v_lshrrev_b32 v5, 2, v1
  v_add_u32 v5, s11, v5
  s_movk_i32 s12, 2752
  v_mul_lo_u32 v5, v5, s12
  v_and_b32 v6, 3, v1
  v_lshl_add_u32 v5, v6, 4, v5
  s_lshl_b32 s11, s3, 11
  s_add_u32 s12, s11, 20480
  s_mov_b32 m0, s12
  s_nop 0
  buffer_load_dwordx4 v5, s[60:63], 0 offen lds
  s_add_u32 s12, s12, 1024
  s_mov_b32 s13, 44032
  s_mov_b32 m0, s12
  s_nop 0
  buffer_load_dwordx4 v5, s[60:63], s13 offen lds
  v_lshlrev_b32 v6, 4, v1
  v_add_u32 v6, s11, v6
  s_mul_i32 s12, s3, 2112
  s_add_u32 s12, s12, 53248
  s_mov_b32 m0, s12
  s_nop 0
  buffer_load_dwordx4 v6, s[64:67], 0 offen nt lds
  s_add_u32 s12, s12, 1056
  s_movk_i32 s13, 1024
  s_mov_b32 m0, s12
  s_nop 0
  buffer_load_dwordx4 v6, s[64:67], s13 offen nt lds
NFD_47:
  s_cmp_eq_u32 s27, 0
  s_cbranch_scc1 L_FIN
  s_cmp_eq_u32 s27, 3
  s_cbranch_scc1 L_FIN
  s_waitcnt vmcnt(0)
  s_barrier
  s_branch L_FIN
L_FIN:
L_END:
  s_endpgm
.section .rodata,"a"
.p2align 6
.amdhsa_kernel sequential_preLN__mha_block_cached__dense_activation_silu__decode_kernel
  .amdhsa_next_free_vgpr 128
  .amdhsa_next_free_sgpr 102
  .amdhsa_accum_offset 128
  .amdhsa_group_segment_fixed_size 0
  .amdhsa_kernarg_size 88
  .amdhsa_user_sgpr_count 2
  .amdhsa_user_sgpr_kernarg_segment_ptr 1
  .amdhsa_system_sgpr_workgroup_id_x 1
.end_amdhsa_kernel
```
